```python
import torch

def _softmax(x, axis=-1):
    return torch.softmax(x, dim=axis)
def _gelu(x):
    return torch.nn.functional.gelu(x, approximate="tanh")
def _silu(x):
    return torch.nn.functional.silu(x)
def _sigmoid(x):
    return torch.sigmoid(x)
def _layernorm(x, axis=-1, eps=1e-5):
    m = x.mean(dim=axis, keepdim=True)
    v = x.var(dim=axis, keepdim=True, unbiased=False)
    return (x - m) / torch.sqrt(v + eps)
def _scatter_add(tgt, idx, src, axis=0):
    return tgt.clone().index_add_(axis, idx, src)
def _segment_sum(src, seg, n):
    out = torch.zeros((n,) + src.shape[1:], dtype=src.dtype)
    return out.index_add_(0, seg, src)
def _pad(x, pw):
    flat = tuple(v for pair in reversed(pw) for v in pair)
    return torch.nn.functional.pad(x, flat)

kernel_name = 'gated_mix__gqa_block_cached__dense_activation_gelu__decode'

def setup_inputs():

    _w = (lambda a: (lambda t: t.to(torch.bfloat16) if t.is_floating_point() else t)(torch.as_tensor(a)))
    def _A_setup():
        B, Sq, D = 8, 1, 512
        Hq, Hkv, Sk, Dh = 32, 8, 4096, 128
        assert Hq % Hkv == 0, (Hq, Hkv)
        return {
            "x": _w((lambda *s: torch.randn(*s, dtype=torch.bfloat16) * 0.05)(B, Sq, D)),
            "k_cache": _w((lambda *s: torch.randn(*s, dtype=torch.bfloat16) * 6.4)(B, Hkv, Sk, Dh)),
            "v_cache": _w((lambda *s: torch.randn(*s, dtype=torch.bfloat16) * 0.2)(B, Hkv, Sk, Dh)),
            "wq": _w((lambda *s: torch.randn(*s, dtype=torch.bfloat16) * 6.4)(D, Hq * Dh) * (D ** -0.5)),
            "wo": _w((lambda *s: torch.randn(*s, dtype=torch.bfloat16) * 0.2)(Hq * Dh, D) * ((Hq * Dh) ** -0.5)),
        }
    _A_in = _A_setup()

    def _B_setup():
        B, S, D, F = 8, 1, 512, 1792
        return {
            "x": _w((lambda *s: torch.randn(*s, dtype=torch.bfloat16) * 0.05)(B, S, D)),
            "w1": _w((lambda *s: torch.randn(*s, dtype=torch.bfloat16) * 3.2)(D, F) * (D ** -0.5)),
            "b1": _w((lambda *s: torch.randn(*s, dtype=torch.bfloat16) * 3.2)(F) * 0.01),
            "w2": _w((lambda *s: torch.randn(*s, dtype=torch.bfloat16) * 0.2)(F, D) * (F ** -0.5)),
            "b2": _w((lambda *s: torch.randn(*s, dtype=torch.bfloat16) * 0.4)(D) * 0.01),
        }
    _B_in = _B_setup()

    return {
        "A_x": _A_in["x"],
        "A_k_cache": _A_in["k_cache"],
        "A_v_cache": _A_in["v_cache"],
        "A_wq": _A_in["wq"],
        "A_wo": _A_in["wo"],
        "B_x": _B_in["x"],
        "B_w1": _B_in["w1"],
        "B_b1": _B_in["b1"],
        "B_w2": _B_in["w2"],
        "B_b2": _B_in["b2"],
        "gate_w": _w((lambda *s: torch.randn(*s, dtype=torch.bfloat16) * 0.05)(512) * 16.0),
    }

def reference(A_x, A_k_cache, A_v_cache, A_wq, A_wo, B_x, B_w1, B_b1, B_w2, B_b2, gate_w):
    def _A_ref(x, k_cache, v_cache, wq, wo):
        B, Sq, D = x.shape
        Hq, Dh = 32, 128
        Hkv = k_cache.shape[1]
        rep = Hq // Hkv
        q = (lambda x, *d: x.permute(*d))((x @ wq).reshape(B, Sq, Hq, Dh), 0, 2, 1, 3)
        k = (lambda x, n, axis: torch.repeat_interleave(x, n, dim=axis))(k_cache, rep, axis=1)
        v = (lambda x, n, axis: torch.repeat_interleave(x, n, dim=axis))(v_cache, rep, axis=1)
        scores = torch.einsum("bhqd,bhkd->bhqk", q, k) * (Dh ** -0.5)
        p = _softmax(scores, axis=-1)
        o = torch.einsum("bhqk,bhkd->bhqd", p, v)
        return (lambda x, *d: x.permute(*d))(o, 0, 2, 1, 3).reshape(B, Sq, Hq * Dh) @ wo

    def _B_ref(x, w1, b1, w2, b2):
        h = torch.einsum("bsd,df->bsf", x, w1) + b1
        h = _gelu(h)
        return torch.einsum("bsf,fd->bsd", h, w2) + b2

    x = A_x
    g = _sigmoid((x * gate_w).sum(-1, keepdims=True))
    a = _A_ref(x, A_k_cache, A_v_cache, A_wq, A_wo)
    b = _B_ref(x, B_w1, B_b1, B_w2, B_b2)
    return g * a + (1 - g) * b
```

```asm
; @launch grid=(256,1,1) block=(256,1,1) lds=102400
.amdgcn_target "amdgcn-amd-amdhsa--gfx950"
.text
.globl gated_mix__gqa_block_cached__dense_activation_gelu__decode_kernel
.p2align 8
.type gated_mix__gqa_block_cached__dense_activation_gelu__decode_kernel,@function
gated_mix__gqa_block_cached__dense_activation_gelu__decode_kernel:
    s_cmp_ge_u32 s2, 256
    s_cbranch_scc1 L_end
    s_load_dwordx16 s[4:19], s[0:1], 0
    s_load_dwordx8 s[20:27], s[0:1], 64
    s_load_dwordx4 s[28:31], s[0:1], 96
    v_lshrrev_b32 v4, 6, v0
    v_and_b32 v1, 63, v0
    v_readfirstlane_b32 s52, v4
    s_and_b32 s53, s2, 7
    s_lshr_b32 s54, s2, 5
    s_bfe_u32 s55, s2, 0x20003
    s_lshr_b32 s57, s2, 3
    s_lshl_b32 s61, s54, 5
    s_lshl_b32 s62, s53, 2
    s_add_u32 s61, s61, s62
    s_add_u32 s61, s61, s55
    s_lshl_b32 s61, s61, 18
    s_lshl_b32 s62, s52, 12
    s_add_u32 s61, s61, s62
    v_and_b32 v2, 3, v1
    v_lshlrev_b32 v2, 4, v2
    v_bfe_u32 v4, v1, 2, 2
    v_lshl_add_u32 v2, v4, 8, v2
    v_lshrrev_b32 v4, 4, v1
    v_lshl_add_u32 v2, v4, 6, v2
    v_add_u32 v2, s61, v2
    v_lshl_add_u32 v3, v1, 4, s61
    s_mov_b32 s59, 0
    s_mov_b32 s34, 0x4000000
    s_mov_b32 s35, 0x20000
    s_getpc_b64 s[62:63]
L_pc0:
    s_sub_u32 s62, s62, L_pc0-gated_mix__gqa_block_cached__dense_activation_gelu__decode_kernel
    s_subb_u32 s63, s63, 0
    s_lshl_b32 s61, s57, 10
    s_lshl_b32 s100, s52, 8
    s_add_u32 s61, s61, s100
    s_min_u32 s61, s61, L_end-gated_mix__gqa_block_cached__dense_activation_gelu__decode_kernel-252
    v_lshl_add_u32 v5, v1, 2, s61
    global_load_dword v9, v5, s[62:63]
    s_waitcnt lgkmcnt(0)
    s_mov_b32 s32, s6
    s_mov_b32 s33, s7
    buffer_load_dwordx4 a[0:3], v2, s[32:35], s59 offen offset:0 nt
    buffer_load_dwordx4 a[4:7], v2, s[32:35], s59 offen offset:1024 nt
    buffer_load_dwordx4 a[8:11], v2, s[32:35], s59 offen offset:2048 nt
    buffer_load_dwordx4 a[12:15], v2, s[32:35], s59 offen offset:3072 nt
    s_cmp_ge_u32 s2, 212
    s_cbranch_scc1 L_pathN
    s_cmp_ge_u32 s57, 23
    s_cbranch_scc1 L_pathH
    s_cmp_ge_u32 s57, 16
    s_cbranch_scc1 L_pathW
    s_cmp_ge_u32 s57, 8
    s_cbranch_scc1 L_pathN
    s_cmp_eq_u32 s57, 3
    s_cbranch_scc1 L_pathS
    s_lshl_b32 s61, s53, 3
    s_add_u32 s61, s61, s57
    s_sub_u32 s62, s2, 184
    s_cmp_lt_u32 s57, 16
    s_cselect_b32 s76, s61, s62
    s_movk_i32 s61, 8192
    s_movk_i32 s62, 3584
    s_cselect_b32 s60, s61, s62
    s_mov_b32 s61, 4194304
    s_mov_b32 s62, 1835008
    s_cselect_b32 s42, s61, s62
    s_mov_b32 s43, 0x20000
    s_lshl_b32 s76, s76, 6
    v_lshrrev_b32 v4, 3, v1
    s_lshl_b32 s61, s52, 7
    v_add_u32 v4, s61, v4
    v_mul_u32_u24 v5, s60, v4
    v_and_b32 v4, 7, v1
    v_bfe_u32 v6, v1, 4, 1
    v_lshlrev_b32 v6, 1, v6
    v_xor_b32 v4, v4, v6
    s_lshl_b32 s61, s76, 1
    v_add_u32 v5, s61, v5
    v_lshl_add_u32 v5, v4, 4, v5
    v_xor_b32 v6, 64, v5
    s_lshl_b32 s62, s60, 3
    s_lshl_b32 s63, s52, 14
    s_mov_b32 s61, 0
    s_cmp_lt_u32 s57, 16
    s_waitcnt lgkmcnt(0)
    s_cselect_b32 s40, s10, s16
    s_cselect_b32 s41, s11, s17
    s_mov_b32 s32, s6
    s_mov_b32 s33, s7
    s_add_u32 m0, s63, 0
    s_nop 0
    buffer_load_dwordx4 v5, s[40:43], s61 offen nt lds
    s_add_u32 s61, s61, s62
    s_add_u32 m0, s63, 1024
    s_nop 0
    buffer_load_dwordx4 v6, s[40:43], s61 offen nt lds
    s_add_u32 s61, s61, s62
    s_add_u32 m0, s63, 2048
    s_nop 0
    buffer_load_dwordx4 v5, s[40:43], s61 offen nt lds
    s_add_u32 s61, s61, s62
    s_add_u32 m0, s63, 3072
    s_nop 0
    buffer_load_dwordx4 v6, s[40:43], s61 offen nt lds
    s_add_u32 s61, s61, s62
    s_add_u32 m0, s63, 4096
    s_nop 0
    buffer_load_dwordx4 v5, s[40:43], s61 offen nt lds
    s_add_u32 s61, s61, s62
    s_add_u32 m0, s63, 5120
    s_nop 0
    buffer_load_dwordx4 v6, s[40:43], s61 offen nt lds
    s_add_u32 s61, s61, s62
    s_add_u32 m0, s63, 6144
    s_nop 0
    buffer_load_dwordx4 v5, s[40:43], s61 offen nt lds
    s_add_u32 s61, s61, s62
    s_add_u32 m0, s63, 7168
    s_nop 0
    buffer_load_dwordx4 v6, s[40:43], s61 offen nt lds
    s_add_u32 s61, s61, s62
    s_add_u32 m0, s63, 8192
    s_nop 0
    buffer_load_dwordx4 v5, s[40:43], s61 offen nt lds
    s_add_u32 s61, s61, s62
    s_add_u32 m0, s63, 9216
    s_nop 0
    buffer_load_dwordx4 v6, s[40:43], s61 offen nt lds
    s_add_u32 s61, s61, s62
    s_add_u32 m0, s63, 10240
    s_nop 0
    buffer_load_dwordx4 v5, s[40:43], s61 offen nt lds
    s_add_u32 s61, s61, s62
    s_add_u32 m0, s63, 11264
    s_nop 0
    buffer_load_dwordx4 v6, s[40:43], s61 offen nt lds
    s_add_u32 s61, s61, s62
    s_add_u32 m0, s63, 12288
    s_nop 0
    buffer_load_dwordx4 v5, s[40:43], s61 offen nt lds
    s_add_u32 s61, s61, s62
    s_add_u32 m0, s63, 13312
    s_nop 0
    buffer_load_dwordx4 v6, s[40:43], s61 offen nt lds
    s_add_u32 s61, s61, s62
    s_add_u32 m0, s63, 14336
    s_nop 0
    buffer_load_dwordx4 v5, s[40:43], s61 offen nt lds
    s_add_u32 s61, s61, s62
    s_add_u32 m0, s63, 15360
    s_nop 0
    buffer_load_dwordx4 v6, s[40:43], s61 offen nt lds
    s_lshl_b32 s61, s52, 11
    v_lshl_add_u32 v7, v1, 4, s61
    s_mul_i32 s61, s52, 2080
    s_add_u32 m0, s61, 81920
    s_nop 0
    global_load_lds_dwordx4 v7, s[4:5]
    s_add_u32 m0, s61, 81936
    s_nop 0
    global_load_lds_dwordx4 v7, s[4:5] offset:1024
    s_mov_b32 s59, 16384
    buffer_load_dwordx4 a[16:19], v2, s[32:35], s59 offen offset:0 nt
    buffer_load_dwordx4 a[20:23], v2, s[32:35], s59 offen offset:1024 nt
    s_min_u32 s61, s76, 1728
    s_lshl_b32 s62, s52, 4
    s_add_u32 s61, s61, s62
    s_lshl_b32 s61, s61, 1
    v_lshrrev_b32 v7, 4, v1
    v_lshl_add_u32 v4, v7, 3, s61
    global_load_dwordx2 v[14:15], v4, s[18:19]
    s_load_dword s58, s[30:31], 0
    s_mov_b32 s36, s8
    s_mov_b32 s37, s9
    s_mov_b32 s38, 0x4000000
    s_mov_b32 s39, 0x20000
    s_mov_b32 s48, s30
    s_mov_b32 s49, s31
    s_mov_b32 s50, 0x10000000
    s_mov_b32 s51, 0x20000
    s_mov_b32 s64, 0x22222222
    s_mov_b32 s65, 0x22222222
    s_mov_b32 s66, 0x44444444
    s_mov_b32 s67, 0x44444444
    s_mov_b32 s68, 0x88888888
    s_mov_b32 s69, 0x88888888
    s_mov_b32 s70, 0x05040100
    s_mov_b32 s71, 0x07060302
    s_mov_b32 s72, 0x3fb8aa3b
    s_mov_b32 s73, 1048576
    s_getreg_b32 s56, hwreg(HW_REG_XCC_ID, 0, 4)
    s_mov_b32 s44, s12
    s_mov_b32 s45, s13
    s_mov_b32 s46, 4194304
    s_mov_b32 s47, 0x20000
    s_lshl_b32 s77, s53, 5
    s_add_u32 s77, s77, s57
    s_lshl_b32 s61, s77, 10
    s_lshl_b32 s62, s52, 8
    s_add_u32 s61, s61, s62
    s_add_u32 s61, s61, 327680
    v_lshl_add_u32 v8, v1, 2, s61
    s_lshl_b32 s61, s53, 2
    s_add_u32 s78, s61, s55
    s_lshr_b32 s61, s55, 1
    s_lshl_b32 s61, s61, 5
    s_and_b32 s62, s55, 1
    s_lshl_b32 s62, s62, 3
    s_add_u32 s79, s61, s62
    v_and_b32 v12, 3, v1
    v_lshlrev_b32 v12, 1, v12
    v_and_b32 v5, 16, v1
    v_add_u32 v12, v12, v5
    v_lshrrev_b32 v5, 5, v1
    v_add3_u32 v12, v12, v5, s79
    v_mov_b32 v5, -1
    buffer_store_dword v5, v8, s[48:51], 0 offen
    v_lshlrev_b32 v4, 3, v7
    v_bfe_u32 v5, v1, 2, 2
    v_add_u32 v4, v4, v5
    v_lshlrev_b32 v4, 7, v4
    v_and_b32 v5, 3, v1
    v_lshl_add_u32 v4, v5, 3, v4
    v_bfe_u32 v5, v1, 3, 2
    v_xor_b32 v5, s52, v5
    v_lshl_add_u32 v4, v5, 5, v4
    v_and_b32 v5, 7, v1
    v_mul_u32_u24 v6, 1040, v5
    v_lshl_add_u32 v6, v7, 4, v6
    v_add_u32 v6, 81920, v6
    s_cmp_lt_u32 s57, 16
    s_movk_i32 s61, 16384
    s_movk_i32 s62, 7168
    s_cselect_b32 s61, s61, s62
    s_mov_b32 s62, 65536
    s_mov_b32 s63, 196608
    s_cselect_b32 s62, s62, s63
    s_lshl_b32 s63, s76, 2
    s_add_u32 s62, s62, s63
    s_lshl_b32 s63, s52, 6
    s_add_u32 s62, s62, s63
    v_mul_u32_u24 v13, s61, v5
    v_lshl_add_u32 v13, v7, 4, v13
    v_add_u32 v13, s62, v13
    s_waitcnt vmcnt(25)
    buffer_load_dwordx4 a[24:27], v2, s[32:35], s59 offen offset:2048 nt
    s_waitcnt vmcnt(25)
    buffer_load_dwordx4 a[28:31], v2, s[32:35], s59 offen offset:3072 nt
    s_mov_b32 s59, 32768
    s_waitcnt vmcnt(25)
    buffer_load_dwordx4 a[32:35], v2, s[32:35], s59 offen offset:0 nt
    s_waitcnt vmcnt(25)
    buffer_load_dwordx4 a[36:39], v2, s[32:35], s59 offen offset:1024 nt
    s_waitcnt vmcnt(7)
    buffer_load_dwordx4 a[40:43], v2, s[32:35], s59 offen offset:2048 nt
    s_waitcnt vmcnt(7)
    buffer_load_dwordx4 a[44:47], v2, s[32:35], s59 offen offset:3072 nt
    s_mov_b32 s59, 49152
    s_waitcnt vmcnt(5)
    buffer_load_dwordx4 a[48:51], v2, s[32:35], s59 offen offset:0 nt
    s_waitcnt lgkmcnt(0)
    s_add_u32 s58, s58, 1
    s_waitcnt vmcnt(10)
    s_barrier
    s_waitcnt vmcnt(5)
    buffer_load_dwordx4 a[52:55], v2, s[32:35], s59 offen offset:1024 nt
    s_waitcnt vmcnt(5)
    buffer_load_dwordx4 a[56:59], v2, s[32:35], s59 offen offset:2048 nt
    ds_read_b64_tr_b16 v[96:97], v4 offset:0
    ds_read_b64_tr_b16 v[98:99], v4 offset:512
    ds_read_b128 v[160:163], v6 offset:0
    ds_read_b64_tr_b16 v[100:101], v4 offset:4096
    ds_read_b64_tr_b16 v[102:103], v4 offset:4608
    ds_read_b128 v[164:167], v6 offset:64
    ds_read_b64_tr_b16 v[104:105], v4 offset:8192
    ds_read_b64_tr_b16 v[106:107], v4 offset:8704
    ds_read_b128 v[168:171], v6 offset:128
    ds_read_b64_tr_b16 v[108:109], v4 offset:12288
    ds_read_b64_tr_b16 v[110:111], v4 offset:12800
    ds_read_b128 v[172:175], v6 offset:192
    ds_read_b64_tr_b16 v[112:113], v4 offset:16384
    ds_read_b64_tr_b16 v[114:115], v4 offset:16896
    ds_read_b128 v[176:179], v6 offset:256
    ds_read_b64_tr_b16 v[116:117], v4 offset:20480
    ds_read_b64_tr_b16 v[118:119], v4 offset:20992
    ds_read_b128 v[180:183], v6 offset:320
    ds_read_b64_tr_b16 v[120:121], v4 offset:24576
    ds_read_b64_tr_b16 v[122:123], v4 offset:25088
    ds_read_b128 v[184:187], v6 offset:384
    ds_read_b64_tr_b16 v[124:125], v4 offset:28672
    ds_read_b64_tr_b16 v[126:127], v4 offset:29184
    ds_read_b128 v[188:191], v6 offset:448
    ds_read_b64_tr_b16 v[128:129], v4 offset:32768
    ds_read_b64_tr_b16 v[130:131], v4 offset:33280
    ds_read_b128 v[192:195], v6 offset:512
    ds_read_b64_tr_b16 v[132:133], v4 offset:36864
    ds_read_b64_tr_b16 v[134:135], v4 offset:37376
    ds_read_b128 v[196:199], v6 offset:576
    ds_read_b64_tr_b16 v[136:137], v4 offset:40960
    ds_read_b64_tr_b16 v[138:139], v4 offset:41472
    ds_read_b128 v[200:203], v6 offset:640
    ds_read_b64_tr_b16 v[140:141], v4 offset:45056
    ds_read_b64_tr_b16 v[142:143], v4 offset:45568
    ds_read_b128 v[204:207], v6 offset:704
    ds_read_b64_tr_b16 v[144:145], v4 offset:49152
    ds_read_b64_tr_b16 v[146:147], v4 offset:49664
    ds_read_b128 v[208:211], v6 offset:768
    ds_read_b64_tr_b16 v[148:149], v4 offset:53248
    ds_read_b64_tr_b16 v[150:151], v4 offset:53760
    ds_read_b128 v[212:215], v6 offset:832
    ds_read_b64_tr_b16 v[152:153], v4 offset:57344
    ds_read_b64_tr_b16 v[154:155], v4 offset:57856
    ds_read_b128 v[216:219], v6 offset:896
    ds_read_b64_tr_b16 v[156:157], v4 offset:61440
    ds_read_b64_tr_b16 v[158:159], v4 offset:61952
    ds_read_b128 v[220:223], v6 offset:960
    s_waitcnt vmcnt(5)
    buffer_load_dwordx4 a[60:63], v2, s[32:35], s59 offen offset:3072 nt
    s_waitcnt lgkmcnt(0)
    v_mfma_f32_16x16x32_bf16 v[224:227], v[96:99], v[160:163], 0
    v_mfma_f32_16x16x32_bf16 v[228:231], v[100:103], v[164:167], 0
    v_mfma_f32_16x16x32_bf16 v[224:227], v[104:107], v[168:171], v[224:227]
    v_mfma_f32_16x16x32_bf16 v[228:231], v[108:111], v[172:175], v[228:231]
    v_mfma_f32_16x16x32_bf16 v[224:227], v[112:115], v[176:179], v[224:227]
    v_mfma_f32_16x16x32_bf16 v[228:231], v[116:119], v[180:183], v[228:231]
    v_mfma_f32_16x16x32_bf16 v[224:227], v[120:123], v[184:187], v[224:227]
    v_mfma_f32_16x16x32_bf16 v[228:231], v[124:127], v[188:191], v[228:231]
    v_mfma_f32_16x16x32_bf16 v[224:227], v[128:131], v[192:195], v[224:227]
    v_mfma_f32_16x16x32_bf16 v[228:231], v[132:135], v[196:199], v[228:231]
    v_mfma_f32_16x16x32_bf16 v[224:227], v[136:139], v[200:203], v[224:227]
    v_mfma_f32_16x16x32_bf16 v[228:231], v[140:143], v[204:207], v[228:231]
    v_mfma_f32_16x16x32_bf16 v[224:227], v[144:147], v[208:211], v[224:227]
    v_mfma_f32_16x16x32_bf16 v[228:231], v[148:151], v[212:215], v[228:231]
    v_mfma_f32_16x16x32_bf16 v[224:227], v[152:155], v[216:219], v[224:227]
    v_mfma_f32_16x16x32_bf16 v[228:231], v[156:159], v[220:223], v[228:231]
    s_mov_b32 s59, 65536
    s_waitcnt vmcnt(5)
    buffer_load_dwordx4 a[64:67], v2, s[32:35], s59 offen offset:0 nt
    v_mov_b32 v237, s58
    v_mov_b32 v239, s58
    s_nop 2
    v_add_f32 v224, v224, v228
    v_add_f32 v225, v225, v229
    v_add_f32 v226, v226, v230
    v_add_f32 v227, v227, v231
    s_cmp_lt_u32 s57, 16
    s_cbranch_scc0 L_h_epiQ
    v_cvt_pk_bf16_f32 v236, v224, v225
    v_cvt_pk_bf16_f32 v238, v226, v227
    s_mov_b32 exec_lo, 0x00ff00ff
    s_mov_b32 exec_hi, 0x00ff00ff
    buffer_store_dwordx4 v[236:239], v13, s[48:51], 0 offen
    s_branch L_qh_pubQ
L_h_epiQ:
    s_waitcnt vmcnt(11)
    v_lshlrev_b32 v232, 16, v14
    v_and_b32 v233, 0xffff0000, v14
    v_lshlrev_b32 v234, 16, v15
    v_and_b32 v235, 0xffff0000, v15
    v_cvt_pk_bf16_f32 v224, v224, v224
    v_and_b32 v224, 0xffff0000, v224
    v_cvt_pk_bf16_f32 v225, v225, v225
    v_and_b32 v225, 0xffff0000, v225
    v_cvt_pk_bf16_f32 v226, v226, v226
    v_and_b32 v226, 0xffff0000, v226
    v_cvt_pk_bf16_f32 v227, v227, v227
    v_and_b32 v227, 0xffff0000, v227
    v_add_f32 v224, v224, v232
    v_add_f32 v225, v225, v233
    v_add_f32 v226, v226, v234
    v_add_f32 v227, v227, v235
    v_cvt_pk_bf16_f32 v224, v224, v224
    v_and_b32 v224, 0xffff0000, v224
    v_cvt_pk_bf16_f32 v225, v225, v225
    v_and_b32 v225, 0xffff0000, v225
    v_cvt_pk_bf16_f32 v226, v226, v226
    v_and_b32 v226, 0xffff0000, v226
    v_cvt_pk_bf16_f32 v227, v227, v227
    v_and_b32 v227, 0xffff0000, v227
    v_mul_f32 v232, v224, v224
    v_mul_f32 v233, v225, v225
    v_mul_f32 v234, v226, v226
    v_mul_f32 v235, v227, v227
    v_mov_b32 v236, 0xc0135761
    v_fmamk_f32 v232, v232, 0xbdd2d3e8, v236
    v_fmamk_f32 v233, v233, 0xbdd2d3e8, v236
    v_fmamk_f32 v234, v234, 0xbdd2d3e8, v236
    v_fmamk_f32 v235, v235, 0xbdd2d3e8, v236
    v_mul_f32 v232, v232, v224
    v_mul_f32 v233, v233, v225
    v_mul_f32 v234, v234, v226
    v_mul_f32 v235, v235, v227
    v_exp_f32 v232, v232
    v_exp_f32 v233, v233
    v_exp_f32 v234, v234
    v_exp_f32 v235, v235
    v_add_f32 v232, 1.0, v232
    v_add_f32 v233, 1.0, v233
    v_add_f32 v234, 1.0, v234
    v_add_f32 v235, 1.0, v235
    v_rcp_f32 v232, v232
    v_rcp_f32 v233, v233
    v_rcp_f32 v234, v234
    v_rcp_f32 v235, v235
    v_mul_f32 v224, v224, v232
    v_mul_f32 v225, v225, v233
    v_mul_f32 v226, v226, v234
    v_mul_f32 v227, v227, v235
    v_cvt_pk_bf16_f32 v236, v224, v225
    v_cvt_pk_bf16_f32 v238, v226, v227
    s_mov_b32 exec_lo, 0x00ff00ff
    s_mov_b32 exec_hi, 0x00ff00ff
    buffer_store_dwordx4 v[236:239], v13, s[48:51], 0 offen sc1
L_qh_pubQ:
    s_mov_b64 exec, -1
L_qh_doneQ:
    s_waitcnt vmcnt(5)
    buffer_load_dwordx4 a[68:71], v2, s[32:35], s59 offen offset:1024 nt
    s_waitcnt vmcnt(5)
    buffer_load_dwordx4 a[72:75], v2, s[32:35], s59 offen offset:2048 nt
    s_waitcnt vmcnt(5)
    buffer_load_dwordx4 a[76:79], v2, s[32:35], s59 offen offset:3072 nt
    s_mov_b32 s59, 81920
    s_waitcnt vmcnt(5)
    buffer_load_dwordx4 a[80:83], v2, s[32:35], s59 offen offset:0 nt
    s_waitcnt vmcnt(5)
    buffer_load_dwordx4 a[84:87], v2, s[32:35], s59 offen offset:1024 nt
    s_waitcnt vmcnt(5)
    buffer_load_dwordx4 a[88:91], v2, s[32:35], s59 offen offset:2048 nt
    s_waitcnt vmcnt(5)
    buffer_load_dwordx4 a[92:95], v2, s[32:35], s59 offen offset:3072 nt
    s_mov_b32 s59, 98304
    s_waitcnt vmcnt(5)
    buffer_load_dwordx4 a[96:99], v2, s[32:35], s59 offen offset:0 nt
    s_waitcnt vmcnt(5)
    buffer_load_dwordx4 a[100:103], v2, s[32:35], s59 offen offset:1024 nt
    s_waitcnt vmcnt(5)
    buffer_load_dwordx4 a[104:107], v2, s[32:35], s59 offen offset:2048 nt
    s_waitcnt vmcnt(5)
    buffer_load_dwordx4 a[108:111], v2, s[32:35], s59 offen offset:3072 nt
    s_mov_b32 s59, 114688
    s_waitcnt vmcnt(5)
    buffer_load_dwordx4 a[112:115], v2, s[32:35], s59 offen offset:0 nt
    s_waitcnt vmcnt(5)
    buffer_load_dwordx4 a[116:119], v2, s[32:35], s59 offen offset:1024 nt
    s_waitcnt vmcnt(5)
    buffer_load_dwordx4 a[120:123], v2, s[32:35], s59 offen offset:2048 nt
    s_waitcnt vmcnt(5)
    buffer_load_dwordx4 a[124:127], v2, s[32:35], s59 offen offset:3072 nt
    s_mov_b32 s59, 131072
    s_waitcnt vmcnt(5)
    buffer_load_dwordx4 a[128:131], v2, s[32:35], s59 offen offset:0 nt
    s_waitcnt vmcnt(5)
    buffer_load_dwordx4 a[132:135], v2, s[32:35], s59 offen offset:1024 nt
    s_waitcnt vmcnt(5)
    buffer_load_dwordx4 a[136:139], v2, s[32:35], s59 offen offset:2048 nt
    s_waitcnt vmcnt(5)
    buffer_load_dwordx4 a[140:143], v2, s[32:35], s59 offen offset:3072 nt
    s_mov_b32 s59, 147456
    s_waitcnt vmcnt(5)
    buffer_load_dwordx4 a[144:147], v2, s[32:35], s59 offen offset:0 nt
    s_waitcnt vmcnt(5)
    buffer_load_dwordx4 a[148:151], v2, s[32:35], s59 offen offset:1024 nt
    s_waitcnt vmcnt(5)
    buffer_load_dwordx4 a[152:155], v2, s[32:35], s59 offen offset:2048 nt
    s_waitcnt vmcnt(5)
    buffer_load_dwordx4 a[156:159], v2, s[32:35], s59 offen offset:3072 nt
    s_mov_b32 s59, 163840
    s_waitcnt vmcnt(5)
    buffer_load_dwordx4 a[160:163], v2, s[32:35], s59 offen offset:0 nt
    s_waitcnt vmcnt(5)
    buffer_load_dwordx4 a[164:167], v2, s[32:35], s59 offen offset:1024 nt
    s_waitcnt vmcnt(5)
    buffer_load_dwordx4 a[168:171], v2, s[32:35], s59 offen offset:2048 nt
    s_waitcnt vmcnt(5)
    buffer_load_dwordx4 a[172:175], v2, s[32:35], s59 offen offset:3072 nt
    s_lshl_b32 s61, s54, 14
    s_lshl_b32 s62, s53, 11
    s_add_u32 s61, s61, s62
    s_add_u32 s61, s61, 65536
    v_bfe_u32 v15, v1, 2, 2
    v_lshlrev_b32 v15, 9, v15
    v_lshrrev_b32 v6, 4, v1
    v_lshl_add_u32 v15, v6, 7, v15
    v_and_b32 v7, 3, v1
    v_lshl_add_u32 v15, v7, 5, v15
    v_add_u32 v15, s61, v15
    s_mov_b32 s59, 180224
    s_waitcnt vmcnt(5)
    buffer_load_dwordx4 a[176:179], v2, s[32:35], s59 offen offset:0 nt
    s_waitcnt vmcnt(5)
    buffer_load_dwordx4 a[180:183], v2, s[32:35], s59 offen offset:1024 nt
    s_waitcnt vmcnt(5)
    buffer_load_dwordx4 a[184:187], v2, s[32:35], s59 offen offset:2048 nt
    s_waitcnt vmcnt(5)
    buffer_load_dwordx4 a[188:191], v2, s[32:35], s59 offen offset:3072 nt
    s_mov_b32 s59, 196608
    s_waitcnt vmcnt(5)
    buffer_load_dwordx4 a[192:195], v2, s[32:35], s59 offen offset:0 nt
    s_waitcnt vmcnt(5)
    buffer_load_dwordx4 a[196:199], v2, s[32:35], s59 offen offset:1024 nt
    s_waitcnt vmcnt(5)
    buffer_load_dwordx4 a[200:203], v2, s[32:35], s59 offen offset:2048 nt
    s_waitcnt vmcnt(5)
    buffer_load_dwordx4 a[204:207], v2, s[32:35], s59 offen offset:3072 nt
    s_mov_b32 s59, 212992
    s_waitcnt vmcnt(5)
    buffer_load_dwordx4 a[208:211], v2, s[32:35], s59 offen offset:0 nt
    s_waitcnt vmcnt(5)
    buffer_load_dwordx4 a[212:215], v2, s[32:35], s59 offen offset:1024 nt
    s_waitcnt vmcnt(5)
    buffer_load_dwordx4 a[216:219], v2, s[32:35], s59 offen offset:2048 nt
    s_waitcnt vmcnt(5)
    buffer_load_dwordx4 a[220:223], v2, s[32:35], s59 offen offset:3072 nt
    s_mov_b32 s59, 229376
    s_waitcnt vmcnt(5)
    buffer_load_dwordx4 a[224:227], v2, s[32:35], s59 offen offset:0 nt
    s_waitcnt vmcnt(5)
    buffer_load_dwordx4 a[228:231], v2, s[32:35], s59 offen offset:1024 nt
    s_waitcnt vmcnt(5)
    buffer_load_dwordx4 a[232:235], v2, s[32:35], s59 offen offset:2048 nt
    s_waitcnt vmcnt(5)
    buffer_load_dwordx4 a[236:239], v2, s[32:35], s59 offen offset:3072 nt
    s_mov_b32 s59, 245760
    s_waitcnt vmcnt(5)
    buffer_load_dwordx4 a[240:243], v2, s[32:35], s59 offen offset:0 nt
    s_waitcnt vmcnt(5)
    buffer_load_dwordx4 a[244:247], v2, s[32:35], s59 offen offset:1024 nt
    s_waitcnt vmcnt(5)
    buffer_load_dwordx4 a[248:251], v2, s[32:35], s59 offen offset:2048 nt
    s_waitcnt vmcnt(5)
    buffer_load_dwordx4 a[252:255], v2, s[32:35], s59 offen offset:3072 nt
    buffer_load_dwordx4 v[80:83], v15, s[48:51], 0 offen sc1
    buffer_load_dwordx4 v[84:87], v15, s[48:51], 0 offen offset:16 sc1
    s_mov_b32 s59, 0
    s_waitcnt vmcnt(8)
    buffer_load_dwordx4 v[96:99], v3, s[36:39], s59 offen offset:0 nt
    s_waitcnt vmcnt(8)
    buffer_load_dwordx4 v[100:103], v3, s[36:39], s59 offen offset:1024 nt
    s_waitcnt vmcnt(8)
    buffer_load_dwordx4 v[104:107], v3, s[36:39], s59 offen offset:2048 nt
    s_waitcnt vmcnt(8)
    buffer_load_dwordx4 v[108:111], v3, s[36:39], s59 offen offset:3072 nt
    s_mov_b32 s59, 16384
    s_waitcnt vmcnt(8)
    buffer_load_dwordx4 v[112:115], v3, s[36:39], s59 offen offset:0 nt
    s_waitcnt vmcnt(8)
    buffer_load_dwordx4 v[116:119], v3, s[36:39], s59 offen offset:1024 nt
    s_waitcnt vmcnt(8)
    buffer_load_dwordx4 v[120:123], v3, s[36:39], s59 offen offset:2048 nt
    s_waitcnt vmcnt(6)
    buffer_load_dwordx4 v[124:127], v3, s[36:39], s59 offen offset:3072 nt
    s_mov_b32 s59, 32768
    s_waitcnt vmcnt(6)
    buffer_load_dwordx4 v[128:131], v3, s[36:39], s59 offen offset:0 nt
    s_waitcnt vmcnt(6)
    buffer_load_dwordx4 v[132:135], v3, s[36:39], s59 offen offset:1024 nt
    s_waitcnt vmcnt(6)
    buffer_load_dwordx4 v[136:139], v3, s[36:39], s59 offen offset:2048 nt
    s_waitcnt vmcnt(6)
    buffer_load_dwordx4 v[140:143], v3, s[36:39], s59 offen offset:3072 nt
    s_mov_b32 s59, 49152
    s_waitcnt vmcnt(6)
    buffer_load_dwordx4 v[144:147], v3, s[36:39], s59 offen offset:0 nt
    s_waitcnt vmcnt(6)
    buffer_load_dwordx4 v[148:151], v3, s[36:39], s59 offen offset:1024 nt
    s_waitcnt vmcnt(6)
    buffer_load_dwordx4 v[152:155], v3, s[36:39], s59 offen offset:2048 nt
    s_waitcnt vmcnt(6)
    buffer_load_dwordx4 v[156:159], v3, s[36:39], s59 offen offset:3072 nt
    s_branch L_join
L_pathS:
    s_lshl_b32 s61, s53, 3
    s_add_u32 s61, s61, s57
    s_sub_u32 s62, s2, 184
    s_cmp_lt_u32 s57, 16
    s_cselect_b32 s76, s61, s62
    s_movk_i32 s61, 8192
    s_movk_i32 s62, 3584
    s_cselect_b32 s60, s61, s62
    s_mov_b32 s61, 4194304
    s_mov_b32 s62, 1835008
    s_cselect_b32 s42, s61, s62
    s_mov_b32 s43, 0x20000
    s_lshl_b32 s76, s76, 6
    v_lshrrev_b32 v4, 3, v1
    s_lshl_b32 s61, s52, 7
    v_add_u32 v4, s61, v4
    v_mul_u32_u24 v5, s60, v4
    v_and_b32 v4, 7, v1
    v_bfe_u32 v6, v1, 4, 1
    v_lshlrev_b32 v6, 1, v6
    v_xor_b32 v4, v4, v6
    s_lshl_b32 s61, s76, 1
    v_add_u32 v5, s61, v5
    v_lshl_add_u32 v5, v4, 4, v5
    v_xor_b32 v6, 64, v5
    s_lshl_b32 s62, s60, 3
    s_lshl_b32 s63, s52, 14
    s_mov_b32 s61, 0
    s_cmp_lt_u32 s57, 16
    s_waitcnt lgkmcnt(0)
    s_cselect_b32 s40, s10, s16
    s_cselect_b32 s41, s11, s17
    s_mov_b32 s32, s6
    s_mov_b32 s33, s7
    s_add_u32 m0, s63, 0
    s_nop 0
    buffer_load_dwordx4 v5, s[40:43], s61 offen nt lds
    s_add_u32 s61, s61, s62
    s_add_u32 m0, s63, 1024
    s_nop 0
    buffer_load_dwordx4 v6, s[40:43], s61 offen nt lds
    s_add_u32 s61, s61, s62
    s_add_u32 m0, s63, 2048
    s_nop 0
    buffer_load_dwordx4 v5, s[40:43], s61 offen nt lds
    s_add_u32 s61, s61, s62
    s_add_u32 m0, s63, 3072
    s_nop 0
    buffer_load_dwordx4 v6, s[40:43], s61 offen nt lds
    s_add_u32 s61, s61, s62
    s_add_u32 m0, s63, 4096
    s_nop 0
    buffer_load_dwordx4 v5, s[40:43], s61 offen nt lds
    s_add_u32 s61, s61, s62
    s_add_u32 m0, s63, 5120
    s_nop 0
    buffer_load_dwordx4 v6, s[40:43], s61 offen nt lds
    s_add_u32 s61, s61, s62
    s_add_u32 m0, s63, 6144
    s_nop 0
    buffer_load_dwordx4 v5, s[40:43], s61 offen nt lds
    s_add_u32 s61, s61, s62
    s_add_u32 m0, s63, 7168
    s_nop 0
    buffer_load_dwordx4 v6, s[40:43], s61 offen nt lds
    s_add_u32 s61, s61, s62
    s_add_u32 m0, s63, 8192
    s_nop 0
    buffer_load_dwordx4 v5, s[40:43], s61 offen nt lds
    s_add_u32 s61, s61, s62
    s_add_u32 m0, s63, 9216
    s_nop 0
    buffer_load_dwordx4 v6, s[40:43], s61 offen nt lds
    s_add_u32 s61, s61, s62
    s_add_u32 m0, s63, 10240
    s_nop 0
    buffer_load_dwordx4 v5, s[40:43], s61 offen nt lds
    s_add_u32 s61, s61, s62
    s_add_u32 m0, s63, 11264
    s_nop 0
    buffer_load_dwordx4 v6, s[40:43], s61 offen nt lds
    s_add_u32 s61, s61, s62
    s_add_u32 m0, s63, 12288
    s_nop 0
    buffer_load_dwordx4 v5, s[40:43], s61 offen nt lds
    s_add_u32 s61, s61, s62
    s_add_u32 m0, s63, 13312
    s_nop 0
    buffer_load_dwordx4 v6, s[40:43], s61 offen nt lds
    s_add_u32 s61, s61, s62
    s_add_u32 m0, s63, 14336
    s_nop 0
    buffer_load_dwordx4 v5, s[40:43], s61 offen nt lds
    s_add_u32 s61, s61, s62
    s_add_u32 m0, s63, 15360
    s_nop 0
    buffer_load_dwordx4 v6, s[40:43], s61 offen nt lds
    s_lshl_b32 s61, s52, 11
    v_lshl_add_u32 v7, v1, 4, s61
    s_mul_i32 s61, s52, 2080
    s_add_u32 m0, s61, 81920
    s_nop 0
    global_load_lds_dwordx4 v7, s[4:5]
    s_add_u32 m0, s61, 81936
    s_nop 0
    global_load_lds_dwordx4 v7, s[4:5] offset:1024
    s_mov_b32 s59, 16384
    buffer_load_dwordx4 a[16:19], v2, s[32:35], s59 offen offset:0 nt
    buffer_load_dwordx4 a[20:23], v2, s[32:35], s59 offen offset:1024 nt
    s_min_u32 s61, s76, 1728
    s_lshl_b32 s62, s52, 4
    s_add_u32 s61, s61, s62
    s_lshl_b32 s61, s61, 1
    v_lshrrev_b32 v7, 4, v1
    v_lshl_add_u32 v4, v7, 3, s61
    global_load_dwordx2 v[14:15], v4, s[18:19]
    s_load_dword s58, s[30:31], 0
    s_mov_b32 s36, s8
    s_mov_b32 s37, s9
    s_mov_b32 s38, 0x4000000
    s_mov_b32 s39, 0x20000
    s_mov_b32 s48, s30
    s_mov_b32 s49, s31
    s_mov_b32 s50, 0x10000000
    s_mov_b32 s51, 0x20000
    s_mov_b32 s64, 0x22222222
    s_mov_b32 s65, 0x22222222
    s_mov_b32 s66, 0x44444444
    s_mov_b32 s67, 0x44444444
    s_mov_b32 s68, 0x88888888
    s_mov_b32 s69, 0x88888888
    s_mov_b32 s70, 0x05040100
    s_mov_b32 s71, 0x07060302
    s_mov_b32 s72, 0x3fb8aa3b
    s_mov_b32 s73, 1048576
    s_getreg_b32 s56, hwreg(HW_REG_XCC_ID, 0, 4)
    s_mov_b32 s44, s12
    s_mov_b32 s45, s13
    s_mov_b32 s46, 4194304
    s_mov_b32 s47, 0x20000
    s_lshl_b32 s77, s53, 5
    s_add_u32 s77, s77, s57
    s_lshl_b32 s61, s77, 10
    s_lshl_b32 s62, s52, 8
    s_add_u32 s61, s61, s62
    s_add_u32 s61, s61, 327680
    v_lshl_add_u32 v8, v1, 2, s61
    s_lshl_b32 s61, s53, 2
    s_add_u32 s78, s61, s55
    s_lshr_b32 s61, s55, 1
    s_lshl_b32 s61, s61, 5
    s_and_b32 s62, s55, 1
    s_lshl_b32 s62, s62, 3
    s_add_u32 s79, s61, s62
    v_and_b32 v12, 3, v1
    v_lshlrev_b32 v12, 1, v12
    v_and_b32 v5, 16, v1
    v_add_u32 v12, v12, v5
    v_lshrrev_b32 v5, 5, v1
    v_add3_u32 v12, v12, v5, s79
    v_mov_b32 v5, -1
    buffer_store_dword v5, v8, s[48:51], 0 offen
    v_lshlrev_b32 v4, 3, v7
    v_bfe_u32 v5, v1, 2, 2
    v_add_u32 v4, v4, v5
    v_lshlrev_b32 v4, 7, v4
    v_and_b32 v5, 3, v1
    v_lshl_add_u32 v4, v5, 3, v4
    v_bfe_u32 v5, v1, 3, 2
    v_xor_b32 v5, s52, v5
    v_lshl_add_u32 v4, v5, 5, v4
    v_and_b32 v5, 7, v1
    v_mul_u32_u24 v6, 1040, v5
    v_lshl_add_u32 v6, v7, 4, v6
    v_add_u32 v6, 81920, v6
    s_cmp_lt_u32 s57, 16
    s_movk_i32 s61, 16384
    s_movk_i32 s62, 7168
    s_cselect_b32 s61, s61, s62
    s_mov_b32 s62, 65536
    s_mov_b32 s63, 196608
    s_cselect_b32 s62, s62, s63
    s_lshl_b32 s63, s76, 2
    s_add_u32 s62, s62, s63
    s_lshl_b32 s63, s52, 6
    s_add_u32 s62, s62, s63
    v_mul_u32_u24 v13, s61, v5
    v_lshl_add_u32 v13, v7, 4, v13
    v_add_u32 v13, s62, v13
    buffer_load_dwordx4 a[24:27], v2, s[32:35], s59 offen offset:2048 nt
    buffer_load_dwordx4 a[28:31], v2, s[32:35], s59 offen offset:3072 nt
    s_mov_b32 s59, 32768
    s_waitcnt vmcnt(27)
    buffer_load_dwordx4 a[32:35], v2, s[32:35], s59 offen offset:0 nt
    s_waitcnt vmcnt(27)
    buffer_load_dwordx4 a[36:39], v2, s[32:35], s59 offen offset:1024 nt
    s_waitcnt vmcnt(27)
    buffer_load_dwordx4 a[40:43], v2, s[32:35], s59 offen offset:2048 nt
    s_waitcnt vmcnt(27)
    buffer_load_dwordx4 a[44:47], v2, s[32:35], s59 offen offset:3072 nt
    s_mov_b32 s59, 49152
    s_waitcnt vmcnt(9)
    buffer_load_dwordx4 a[48:51], v2, s[32:35], s59 offen offset:0 nt
    s_waitcnt vmcnt(9)
    buffer_load_dwordx4 a[52:55], v2, s[32:35], s59 offen offset:1024 nt
    s_waitcnt lgkmcnt(0)
    s_add_u32 s58, s58, 1
    s_waitcnt vmcnt(11)
    s_barrier
    s_waitcnt vmcnt(7)
    buffer_load_dwordx4 a[56:59], v2, s[32:35], s59 offen offset:2048 nt
    s_waitcnt vmcnt(7)
    buffer_load_dwordx4 a[60:63], v2, s[32:35], s59 offen offset:3072 nt
    ds_read_b64_tr_b16 v[96:97], v4 offset:0
    ds_read_b64_tr_b16 v[98:99], v4 offset:512
    ds_read_b128 v[160:163], v6 offset:0
    ds_read_b64_tr_b16 v[100:101], v4 offset:4096
    ds_read_b64_tr_b16 v[102:103], v4 offset:4608
    ds_read_b128 v[164:167], v6 offset:64
    ds_read_b64_tr_b16 v[104:105], v4 offset:8192
    ds_read_b64_tr_b16 v[106:107], v4 offset:8704
    ds_read_b128 v[168:171], v6 offset:128
    ds_read_b64_tr_b16 v[108:109], v4 offset:12288
    ds_read_b64_tr_b16 v[110:111], v4 offset:12800
    ds_read_b128 v[172:175], v6 offset:192
    ds_read_b64_tr_b16 v[112:113], v4 offset:16384
    ds_read_b64_tr_b16 v[114:115], v4 offset:16896
    ds_read_b128 v[176:179], v6 offset:256
    ds_read_b64_tr_b16 v[116:117], v4 offset:20480
    ds_read_b64_tr_b16 v[118:119], v4 offset:20992
    ds_read_b128 v[180:183], v6 offset:320
    ds_read_b64_tr_b16 v[120:121], v4 offset:24576
    ds_read_b64_tr_b16 v[122:123], v4 offset:25088
    ds_read_b128 v[184:187], v6 offset:384
    ds_read_b64_tr_b16 v[124:125], v4 offset:28672
    ds_read_b64_tr_b16 v[126:127], v4 offset:29184
    ds_read_b128 v[188:191], v6 offset:448
    ds_read_b64_tr_b16 v[128:129], v4 offset:32768
    ds_read_b64_tr_b16 v[130:131], v4 offset:33280
    ds_read_b128 v[192:195], v6 offset:512
    ds_read_b64_tr_b16 v[132:133], v4 offset:36864
    ds_read_b64_tr_b16 v[134:135], v4 offset:37376
    ds_read_b128 v[196:199], v6 offset:576
    ds_read_b64_tr_b16 v[136:137], v4 offset:40960
    ds_read_b64_tr_b16 v[138:139], v4 offset:41472
    ds_read_b128 v[200:203], v6 offset:640
    ds_read_b64_tr_b16 v[140:141], v4 offset:45056
    ds_read_b64_tr_b16 v[142:143], v4 offset:45568
    ds_read_b128 v[204:207], v6 offset:704
    ds_read_b64_tr_b16 v[144:145], v4 offset:49152
    ds_read_b64_tr_b16 v[146:147], v4 offset:49664
    ds_read_b128 v[208:211], v6 offset:768
    ds_read_b64_tr_b16 v[148:149], v4 offset:53248
    ds_read_b64_tr_b16 v[150:151], v4 offset:53760
    ds_read_b128 v[212:215], v6 offset:832
    ds_read_b64_tr_b16 v[152:153], v4 offset:57344
    ds_read_b64_tr_b16 v[154:155], v4 offset:57856
    ds_read_b128 v[216:219], v6 offset:896
    ds_read_b64_tr_b16 v[156:157], v4 offset:61440
    ds_read_b64_tr_b16 v[158:159], v4 offset:61952
    ds_read_b128 v[220:223], v6 offset:960
    s_mov_b32 s59, 65536
    s_waitcnt vmcnt(7)
    buffer_load_dwordx4 a[64:67], v2, s[32:35], s59 offen offset:0 nt
    s_waitcnt lgkmcnt(0)
    v_mfma_f32_16x16x32_bf16 v[224:227], v[96:99], v[160:163], 0
    v_mfma_f32_16x16x32_bf16 v[228:231], v[100:103], v[164:167], 0
    v_mfma_f32_16x16x32_bf16 v[224:227], v[104:107], v[168:171], v[224:227]
    v_mfma_f32_16x16x32_bf16 v[228:231], v[108:111], v[172:175], v[228:231]
    v_mfma_f32_16x16x32_bf16 v[224:227], v[112:115], v[176:179], v[224:227]
    v_mfma_f32_16x16x32_bf16 v[228:231], v[116:119], v[180:183], v[228:231]
    v_mfma_f32_16x16x32_bf16 v[224:227], v[120:123], v[184:187], v[224:227]
    v_mfma_f32_16x16x32_bf16 v[228:231], v[124:127], v[188:191], v[228:231]
    v_mfma_f32_16x16x32_bf16 v[224:227], v[128:131], v[192:195], v[224:227]
    v_mfma_f32_16x16x32_bf16 v[228:231], v[132:135], v[196:199], v[228:231]
    v_mfma_f32_16x16x32_bf16 v[224:227], v[136:139], v[200:203], v[224:227]
    v_mfma_f32_16x16x32_bf16 v[228:231], v[140:143], v[204:207], v[228:231]
    v_mfma_f32_16x16x32_bf16 v[224:227], v[144:147], v[208:211], v[224:227]
    v_mfma_f32_16x16x32_bf16 v[228:231], v[148:151], v[212:215], v[228:231]
    v_mfma_f32_16x16x32_bf16 v[224:227], v[152:155], v[216:219], v[224:227]
    v_mfma_f32_16x16x32_bf16 v[228:231], v[156:159], v[220:223], v[228:231]
    s_waitcnt vmcnt(7)
    buffer_load_dwordx4 a[68:71], v2, s[32:35], s59 offen offset:1024 nt
    v_mov_b32 v237, s58
    v_mov_b32 v239, s58
    s_nop 3
    v_add_f32 v224, v224, v228
    v_add_f32 v225, v225, v229
    v_add_f32 v226, v226, v230
    v_add_f32 v227, v227, v231
    s_cmp_lt_u32 s57, 16
    s_cbranch_scc0 L_h_epiS
    v_cvt_pk_bf16_f32 v236, v224, v225
    v_cvt_pk_bf16_f32 v238, v226, v227
    s_mov_b32 exec_lo, 0x00ff00ff
    s_mov_b32 exec_hi, 0x00ff00ff
    buffer_store_dwordx4 v[236:239], v13, s[48:51], 0 offen
    s_branch L_qh_pubS
L_h_epiS:
    s_waitcnt vmcnt(12)
    v_lshlrev_b32 v232, 16, v14
    v_and_b32 v233, 0xffff0000, v14
    v_lshlrev_b32 v234, 16, v15
    v_and_b32 v235, 0xffff0000, v15
    v_cvt_pk_bf16_f32 v224, v224, v224
    v_and_b32 v224, 0xffff0000, v224
    v_cvt_pk_bf16_f32 v225, v225, v225
    v_and_b32 v225, 0xffff0000, v225
    v_cvt_pk_bf16_f32 v226, v226, v226
    v_and_b32 v226, 0xffff0000, v226
    v_cvt_pk_bf16_f32 v227, v227, v227
    v_and_b32 v227, 0xffff0000, v227
    v_add_f32 v224, v224, v232
    v_add_f32 v225, v225, v233
    v_add_f32 v226, v226, v234
    v_add_f32 v227, v227, v235
    v_cvt_pk_bf16_f32 v224, v224, v224
    v_and_b32 v224, 0xffff0000, v224
    v_cvt_pk_bf16_f32 v225, v225, v225
    v_and_b32 v225, 0xffff0000, v225
    v_cvt_pk_bf16_f32 v226, v226, v226
    v_and_b32 v226, 0xffff0000, v226
    v_cvt_pk_bf16_f32 v227, v227, v227
    v_and_b32 v227, 0xffff0000, v227
    v_mul_f32 v232, v224, v224
    v_mul_f32 v233, v225, v225
    v_mul_f32 v234, v226, v226
    v_mul_f32 v235, v227, v227
    v_mov_b32 v236, 0xc0135761
    v_fmamk_f32 v232, v232, 0xbdd2d3e8, v236
    v_fmamk_f32 v233, v233, 0xbdd2d3e8, v236
    v_fmamk_f32 v234, v234, 0xbdd2d3e8, v236
    v_fmamk_f32 v235, v235, 0xbdd2d3e8, v236
    v_mul_f32 v232, v232, v224
    v_mul_f32 v233, v233, v225
    v_mul_f32 v234, v234, v226
    v_mul_f32 v235, v235, v227
    v_exp_f32 v232, v232
    v_exp_f32 v233, v233
    v_exp_f32 v234, v234
    v_exp_f32 v235, v235
    v_add_f32 v232, 1.0, v232
    v_add_f32 v233, 1.0, v233
    v_add_f32 v234, 1.0, v234
    v_add_f32 v235, 1.0, v235
    v_rcp_f32 v232, v232
    v_rcp_f32 v233, v233
    v_rcp_f32 v234, v234
    v_rcp_f32 v235, v235
    v_mul_f32 v224, v224, v232
    v_mul_f32 v225, v225, v233
    v_mul_f32 v226, v226, v234
    v_mul_f32 v227, v227, v235
    v_cvt_pk_bf16_f32 v236, v224, v225
    v_cvt_pk_bf16_f32 v238, v226, v227
    s_mov_b32 exec_lo, 0x00ff00ff
    s_mov_b32 exec_hi, 0x00ff00ff
    buffer_store_dwordx4 v[236:239], v13, s[48:51], 0 offen sc1
L_qh_pubS:
    s_mov_b64 exec, -1
L_qh_doneS:
    s_waitcnt vmcnt(7)
    buffer_load_dwordx4 a[72:75], v2, s[32:35], s59 offen offset:2048 nt
    s_waitcnt vmcnt(7)
    buffer_load_dwordx4 a[76:79], v2, s[32:35], s59 offen offset:3072 nt
    s_mov_b32 s59, 81920
    s_waitcnt vmcnt(7)
    buffer_load_dwordx4 a[80:83], v2, s[32:35], s59 offen offset:0 nt
    s_waitcnt vmcnt(7)
    buffer_load_dwordx4 a[84:87], v2, s[32:35], s59 offen offset:1024 nt
    s_waitcnt vmcnt(7)
    buffer_load_dwordx4 a[88:91], v2, s[32:35], s59 offen offset:2048 nt
    s_waitcnt vmcnt(7)
    buffer_load_dwordx4 a[92:95], v2, s[32:35], s59 offen offset:3072 nt
    s_mov_b32 s59, 98304
    s_waitcnt vmcnt(7)
    buffer_load_dwordx4 a[96:99], v2, s[32:35], s59 offen offset:0 nt
    s_waitcnt vmcnt(7)
    buffer_load_dwordx4 a[100:103], v2, s[32:35], s59 offen offset:1024 nt
    s_waitcnt vmcnt(7)
    buffer_load_dwordx4 a[104:107], v2, s[32:35], s59 offen offset:2048 nt
    s_waitcnt vmcnt(7)
    buffer_load_dwordx4 a[108:111], v2, s[32:35], s59 offen offset:3072 nt
    s_mov_b32 s59, 114688
    s_waitcnt vmcnt(7)
    buffer_load_dwordx4 a[112:115], v2, s[32:35], s59 offen offset:0 nt
    s_waitcnt vmcnt(7)
    buffer_load_dwordx4 a[116:119], v2, s[32:35], s59 offen offset:1024 nt
    s_waitcnt vmcnt(7)
    buffer_load_dwordx4 a[120:123], v2, s[32:35], s59 offen offset:2048 nt
    s_waitcnt vmcnt(7)
    buffer_load_dwordx4 a[124:127], v2, s[32:35], s59 offen offset:3072 nt
    s_mov_b32 s59, 131072
    s_waitcnt vmcnt(7)
    buffer_load_dwordx4 a[128:131], v2, s[32:35], s59 offen offset:0 nt
    s_waitcnt vmcnt(7)
    buffer_load_dwordx4 a[132:135], v2, s[32:35], s59 offen offset:1024 nt
    s_waitcnt vmcnt(7)
    buffer_load_dwordx4 a[136:139], v2, s[32:35], s59 offen offset:2048 nt
    s_waitcnt vmcnt(7)
    buffer_load_dwordx4 a[140:143], v2, s[32:35], s59 offen offset:3072 nt
    s_mov_b32 s59, 147456
    s_waitcnt vmcnt(7)
    buffer_load_dwordx4 a[144:147], v2, s[32:35], s59 offen offset:0 nt
    s_waitcnt vmcnt(7)
    buffer_load_dwordx4 a[148:151], v2, s[32:35], s59 offen offset:1024 nt
    s_waitcnt vmcnt(7)
    buffer_load_dwordx4 a[152:155], v2, s[32:35], s59 offen offset:2048 nt
    s_waitcnt vmcnt(7)
    buffer_load_dwordx4 a[156:159], v2, s[32:35], s59 offen offset:3072 nt
    s_mov_b32 s59, 163840
    s_waitcnt vmcnt(7)
    buffer_load_dwordx4 a[160:163], v2, s[32:35], s59 offen offset:0 nt
    s_waitcnt vmcnt(7)
    buffer_load_dwordx4 a[164:167], v2, s[32:35], s59 offen offset:1024 nt
    s_waitcnt vmcnt(7)
    buffer_load_dwordx4 a[168:171], v2, s[32:35], s59 offen offset:2048 nt
    s_waitcnt vmcnt(7)
    buffer_load_dwordx4 a[172:175], v2, s[32:35], s59 offen offset:3072 nt
    s_lshl_b32 s61, s54, 14
    s_lshl_b32 s62, s53, 11
    s_add_u32 s61, s61, s62
    s_add_u32 s61, s61, 65536
    v_bfe_u32 v15, v1, 2, 2
    v_lshlrev_b32 v15, 9, v15
    v_lshrrev_b32 v6, 4, v1
    v_lshl_add_u32 v15, v6, 7, v15
    v_and_b32 v7, 3, v1
    v_lshl_add_u32 v15, v7, 5, v15
    v_add_u32 v15, s61, v15
    s_mov_b32 s59, 180224
    s_waitcnt vmcnt(7)
    buffer_load_dwordx4 a[176:179], v2, s[32:35], s59 offen offset:0 nt
    s_waitcnt vmcnt(7)
    buffer_load_dwordx4 a[180:183], v2, s[32:35], s59 offen offset:1024 nt
    s_waitcnt vmcnt(7)
    buffer_load_dwordx4 a[184:187], v2, s[32:35], s59 offen offset:2048 nt
    s_waitcnt vmcnt(7)
    buffer_load_dwordx4 a[188:191], v2, s[32:35], s59 offen offset:3072 nt
    s_mov_b32 s59, 196608
    s_waitcnt vmcnt(7)
    buffer_load_dwordx4 a[192:195], v2, s[32:35], s59 offen offset:0 nt
    s_waitcnt vmcnt(7)
    buffer_load_dwordx4 a[196:199], v2, s[32:35], s59 offen offset:1024 nt
    s_waitcnt vmcnt(7)
    buffer_load_dwordx4 a[200:203], v2, s[32:35], s59 offen offset:2048 nt
    s_waitcnt vmcnt(7)
    buffer_load_dwordx4 a[204:207], v2, s[32:35], s59 offen offset:3072 nt
    s_mov_b32 s59, 212992
    s_waitcnt vmcnt(7)
    buffer_load_dwordx4 a[208:211], v2, s[32:35], s59 offen offset:0 nt
    s_waitcnt vmcnt(7)
    buffer_load_dwordx4 a[212:215], v2, s[32:35], s59 offen offset:1024 nt
    s_waitcnt vmcnt(7)
    buffer_load_dwordx4 a[216:219], v2, s[32:35], s59 offen offset:2048 nt
    s_waitcnt vmcnt(7)
    buffer_load_dwordx4 a[220:223], v2, s[32:35], s59 offen offset:3072 nt
    s_mov_b32 s59, 229376
    s_waitcnt vmcnt(7)
    buffer_load_dwordx4 a[224:227], v2, s[32:35], s59 offen offset:0 nt
    s_waitcnt vmcnt(7)
    buffer_load_dwordx4 a[228:231], v2, s[32:35], s59 offen offset:1024 nt
    s_waitcnt vmcnt(7)
    buffer_load_dwordx4 a[232:235], v2, s[32:35], s59 offen offset:2048 nt
    s_waitcnt vmcnt(7)
    buffer_load_dwordx4 a[236:239], v2, s[32:35], s59 offen offset:3072 nt
    s_mov_b32 s59, 245760
    s_waitcnt vmcnt(7)
    buffer_load_dwordx4 a[240:243], v2, s[32:35], s59 offen offset:0 nt
    s_waitcnt vmcnt(7)
    buffer_load_dwordx4 a[244:247], v2, s[32:35], s59 offen offset:1024 nt
    s_waitcnt vmcnt(7)
    buffer_load_dwordx4 a[248:251], v2, s[32:35], s59 offen offset:2048 nt
    s_waitcnt vmcnt(7)
    buffer_load_dwordx4 a[252:255], v2, s[32:35], s59 offen offset:3072 nt
    buffer_load_dwordx4 v[80:83], v15, s[48:51], 0 offen sc1
    buffer_load_dwordx4 v[84:87], v15, s[48:51], 0 offen offset:16 sc1
    s_mov_b32 s59, 0
    s_waitcnt vmcnt(9)
    buffer_load_dwordx4 v[96:99], v3, s[36:39], s59 offen offset:0 nt
    s_waitcnt vmcnt(9)
    buffer_load_dwordx4 v[100:103], v3, s[36:39], s59 offen offset:1024 nt
    s_waitcnt vmcnt(9)
    buffer_load_dwordx4 v[104:107], v3, s[36:39], s59 offen offset:2048 nt
    s_waitcnt vmcnt(9)
    buffer_load_dwordx4 v[108:111], v3, s[36:39], s59 offen offset:3072 nt
    s_mov_b32 s59, 16384
    s_waitcnt vmcnt(9)
    buffer_load_dwordx4 v[112:115], v3, s[36:39], s59 offen offset:0 nt
    s_waitcnt vmcnt(9)
    buffer_load_dwordx4 v[116:119], v3, s[36:39], s59 offen offset:1024 nt
    s_waitcnt vmcnt(9)
    buffer_load_dwordx4 v[120:123], v3, s[36:39], s59 offen offset:2048 nt
    s_waitcnt vmcnt(9)
    buffer_load_dwordx4 v[124:127], v3, s[36:39], s59 offen offset:3072 nt
    s_mov_b32 s59, 32768
    s_waitcnt vmcnt(7)
    buffer_load_dwordx4 v[128:131], v3, s[36:39], s59 offen offset:0 nt
    s_waitcnt vmcnt(7)
    buffer_load_dwordx4 v[132:135], v3, s[36:39], s59 offen offset:1024 nt
    s_waitcnt vmcnt(7)
    buffer_load_dwordx4 v[136:139], v3, s[36:39], s59 offen offset:2048 nt
    s_waitcnt vmcnt(7)
    buffer_load_dwordx4 v[140:143], v3, s[36:39], s59 offen offset:3072 nt
    s_mov_b32 s59, 49152
    s_waitcnt vmcnt(7)
    buffer_load_dwordx4 v[144:147], v3, s[36:39], s59 offen offset:0 nt
    s_waitcnt vmcnt(7)
    buffer_load_dwordx4 v[148:151], v3, s[36:39], s59 offen offset:1024 nt
    s_waitcnt vmcnt(7)
    buffer_load_dwordx4 v[152:155], v3, s[36:39], s59 offen offset:2048 nt
    s_waitcnt vmcnt(7)
    buffer_load_dwordx4 v[156:159], v3, s[36:39], s59 offen offset:3072 nt
    s_branch L_join
L_pathH:
    s_lshl_b32 s61, s53, 3
    s_add_u32 s61, s61, s57
    s_sub_u32 s62, s2, 184
    s_cmp_lt_u32 s57, 16
    s_cselect_b32 s76, s61, s62
    s_movk_i32 s61, 8192
    s_movk_i32 s62, 3584
    s_cselect_b32 s60, s61, s62
    s_mov_b32 s61, 4194304
    s_mov_b32 s62, 1835008
    s_cselect_b32 s42, s61, s62
    s_mov_b32 s43, 0x20000
    s_lshl_b32 s76, s76, 6
    v_lshrrev_b32 v4, 3, v1
    s_lshl_b32 s61, s52, 7
    v_add_u32 v4, s61, v4
    v_mul_u32_u24 v5, s60, v4
    v_and_b32 v4, 7, v1
    v_bfe_u32 v6, v1, 4, 1
    v_lshlrev_b32 v6, 1, v6
    v_xor_b32 v4, v4, v6
    s_lshl_b32 s61, s76, 1
    v_add_u32 v5, s61, v5
    v_lshl_add_u32 v5, v4, 4, v5
    v_xor_b32 v6, 64, v5
    s_lshl_b32 s62, s60, 3
    s_lshl_b32 s63, s52, 14
    s_mov_b32 s61, 0
    s_cmp_lt_u32 s57, 16
    s_waitcnt lgkmcnt(0)
    s_cselect_b32 s40, s10, s16
    s_cselect_b32 s41, s11, s17
    s_mov_b32 s32, s6
    s_mov_b32 s33, s7
    s_add_u32 m0, s63, 0
    s_nop 0
    buffer_load_dwordx4 v5, s[40:43], s61 offen nt lds
    s_add_u32 s61, s61, s62
    s_add_u32 m0, s63, 1024
    s_nop 0
    buffer_load_dwordx4 v6, s[40:43], s61 offen nt lds
    s_add_u32 s61, s61, s62
    s_add_u32 m0, s63, 2048
    s_nop 0
    buffer_load_dwordx4 v5, s[40:43], s61 offen nt lds
    s_add_u32 s61, s61, s62
    s_add_u32 m0, s63, 3072
    s_nop 0
    buffer_load_dwordx4 v6, s[40:43], s61 offen nt lds
    s_add_u32 s61, s61, s62
    s_add_u32 m0, s63, 4096
    s_nop 0
    buffer_load_dwordx4 v5, s[40:43], s61 offen nt lds
    s_add_u32 s61, s61, s62
    s_add_u32 m0, s63, 5120
    s_nop 0
    buffer_load_dwordx4 v6, s[40:43], s61 offen nt lds
    s_add_u32 s61, s61, s62
    s_add_u32 m0, s63, 6144
    s_nop 0
    buffer_load_dwordx4 v5, s[40:43], s61 offen nt lds
    s_add_u32 s61, s61, s62
    s_add_u32 m0, s63, 7168
    s_nop 0
    buffer_load_dwordx4 v6, s[40:43], s61 offen nt lds
    s_add_u32 s61, s61, s62
    s_add_u32 m0, s63, 8192
    s_nop 0
    buffer_load_dwordx4 v5, s[40:43], s61 offen nt lds
    s_add_u32 s61, s61, s62
    s_add_u32 m0, s63, 9216
    s_nop 0
    buffer_load_dwordx4 v6, s[40:43], s61 offen nt lds
    s_add_u32 s61, s61, s62
    s_add_u32 m0, s63, 10240
    s_nop 0
    buffer_load_dwordx4 v5, s[40:43], s61 offen nt lds
    s_add_u32 s61, s61, s62
    s_add_u32 m0, s63, 11264
    s_nop 0
    buffer_load_dwordx4 v6, s[40:43], s61 offen nt lds
    s_add_u32 s61, s61, s62
    s_add_u32 m0, s63, 12288
    s_nop 0
    buffer_load_dwordx4 v5, s[40:43], s61 offen nt lds
    s_add_u32 s61, s61, s62
    s_add_u32 m0, s63, 13312
    s_nop 0
    buffer_load_dwordx4 v6, s[40:43], s61 offen nt lds
    s_add_u32 s61, s61, s62
    s_add_u32 m0, s63, 14336
    s_nop 0
    buffer_load_dwordx4 v5, s[40:43], s61 offen nt lds
    s_add_u32 s61, s61, s62
    s_add_u32 m0, s63, 15360
    s_nop 0
    buffer_load_dwordx4 v6, s[40:43], s61 offen nt lds
    s_lshl_b32 s61, s52, 11
    v_lshl_add_u32 v7, v1, 4, s61
    s_mul_i32 s61, s52, 2080
    s_add_u32 m0, s61, 81920
    s_nop 0
    global_load_lds_dwordx4 v7, s[4:5]
    s_add_u32 m0, s61, 81936
    s_nop 0
    global_load_lds_dwordx4 v7, s[4:5] offset:1024
    s_mov_b32 s59, 16384
    buffer_load_dwordx4 a[16:19], v2, s[32:35], s59 offen offset:0 nt
    buffer_load_dwordx4 a[20:23], v2, s[32:35], s59 offen offset:1024 nt
    s_min_u32 s61, s76, 1728
    s_lshl_b32 s62, s52, 4
    s_add_u32 s61, s61, s62
    s_lshl_b32 s61, s61, 1
    v_lshrrev_b32 v7, 4, v1
    v_lshl_add_u32 v4, v7, 3, s61
    global_load_dwordx2 v[14:15], v4, s[18:19]
    s_load_dword s58, s[30:31], 0
    s_mov_b32 s36, s8
    s_mov_b32 s37, s9
    s_mov_b32 s38, 0x4000000
    s_mov_b32 s39, 0x20000
    s_mov_b32 s48, s30
    s_mov_b32 s49, s31
    s_mov_b32 s50, 0x10000000
    s_mov_b32 s51, 0x20000
    s_mov_b32 s64, 0x22222222
    s_mov_b32 s65, 0x22222222
    s_mov_b32 s66, 0x44444444
    s_mov_b32 s67, 0x44444444
    s_mov_b32 s68, 0x88888888
    s_mov_b32 s69, 0x88888888
    s_mov_b32 s70, 0x05040100
    s_mov_b32 s71, 0x07060302
    s_mov_b32 s72, 0x3fb8aa3b
    s_mov_b32 s73, 1048576
    s_getreg_b32 s56, hwreg(HW_REG_XCC_ID, 0, 4)
    s_mov_b32 s44, s12
    s_mov_b32 s45, s13
    s_mov_b32 s46, 4194304
    s_mov_b32 s47, 0x20000
    s_lshl_b32 s77, s53, 5
    s_add_u32 s77, s77, s57
    s_lshl_b32 s61, s77, 10
    s_lshl_b32 s62, s52, 8
    s_add_u32 s61, s61, s62
    s_add_u32 s61, s61, 327680
    v_lshl_add_u32 v8, v1, 2, s61
    s_lshl_b32 s61, s53, 2
    s_add_u32 s78, s61, s55
    s_lshr_b32 s61, s55, 1
    s_lshl_b32 s61, s61, 5
    s_and_b32 s62, s55, 1
    s_lshl_b32 s62, s62, 3
    s_add_u32 s79, s61, s62
    v_and_b32 v12, 3, v1
    v_lshlrev_b32 v12, 1, v12
    v_and_b32 v5, 16, v1
    v_add_u32 v12, v12, v5
    v_lshrrev_b32 v5, 5, v1
    v_add3_u32 v12, v12, v5, s79
    v_mov_b32 v5, -1
    buffer_store_dword v5, v8, s[48:51], 0 offen
    v_lshlrev_b32 v4, 3, v7
    v_bfe_u32 v5, v1, 2, 2
    v_add_u32 v4, v4, v5
    v_lshlrev_b32 v4, 7, v4
    v_and_b32 v5, 3, v1
    v_lshl_add_u32 v4, v5, 3, v4
    v_bfe_u32 v5, v1, 3, 2
    v_xor_b32 v5, s52, v5
    v_lshl_add_u32 v4, v5, 5, v4
    v_and_b32 v5, 7, v1
    v_mul_u32_u24 v6, 1040, v5
    v_lshl_add_u32 v6, v7, 4, v6
    v_add_u32 v6, 81920, v6
    s_cmp_lt_u32 s57, 16
    s_movk_i32 s61, 16384
    s_movk_i32 s62, 7168
    s_cselect_b32 s61, s61, s62
    s_mov_b32 s62, 65536
    s_mov_b32 s63, 196608
    s_cselect_b32 s62, s62, s63
    s_lshl_b32 s63, s76, 2
    s_add_u32 s62, s62, s63
    s_lshl_b32 s63, s52, 6
    s_add_u32 s62, s62, s63
    v_mul_u32_u24 v13, s61, v5
    v_lshl_add_u32 v13, v7, 4, v13
    v_add_u32 v13, s62, v13
    s_waitcnt vmcnt(25)
    buffer_load_dwordx4 a[24:27], v2, s[32:35], s59 offen offset:2048 nt
    s_waitcnt vmcnt(25)
    buffer_load_dwordx4 a[28:31], v2, s[32:35], s59 offen offset:3072 nt
    s_mov_b32 s59, 32768
    s_waitcnt vmcnt(25)
    buffer_load_dwordx4 a[32:35], v2, s[32:35], s59 offen offset:0 nt
    s_waitcnt vmcnt(25)
    buffer_load_dwordx4 a[36:39], v2, s[32:35], s59 offen offset:1024 nt
    s_waitcnt vmcnt(7)
    buffer_load_dwordx4 a[40:43], v2, s[32:35], s59 offen offset:2048 nt
    s_waitcnt vmcnt(7)
    buffer_load_dwordx4 a[44:47], v2, s[32:35], s59 offen offset:3072 nt
    s_mov_b32 s59, 49152
    s_waitcnt vmcnt(5)
    buffer_load_dwordx4 a[48:51], v2, s[32:35], s59 offen offset:0 nt
    s_waitcnt lgkmcnt(0)
    s_add_u32 s58, s58, 1
    s_waitcnt vmcnt(10)
    s_barrier
    s_waitcnt vmcnt(5)
    buffer_load_dwordx4 a[52:55], v2, s[32:35], s59 offen offset:1024 nt
    s_waitcnt vmcnt(5)
    buffer_load_dwordx4 a[56:59], v2, s[32:35], s59 offen offset:2048 nt
    ds_read_b64_tr_b16 v[96:97], v4 offset:0
    ds_read_b64_tr_b16 v[98:99], v4 offset:512
    ds_read_b128 v[160:163], v6 offset:0
    ds_read_b64_tr_b16 v[100:101], v4 offset:4096
    ds_read_b64_tr_b16 v[102:103], v4 offset:4608
    ds_read_b128 v[164:167], v6 offset:64
    ds_read_b64_tr_b16 v[104:105], v4 offset:8192
    ds_read_b64_tr_b16 v[106:107], v4 offset:8704
    ds_read_b128 v[168:171], v6 offset:128
    ds_read_b64_tr_b16 v[108:109], v4 offset:12288
    ds_read_b64_tr_b16 v[110:111], v4 offset:12800
    ds_read_b128 v[172:175], v6 offset:192
    ds_read_b64_tr_b16 v[112:113], v4 offset:16384
    ds_read_b64_tr_b16 v[114:115], v4 offset:16896
    ds_read_b128 v[176:179], v6 offset:256
    ds_read_b64_tr_b16 v[116:117], v4 offset:20480
    ds_read_b64_tr_b16 v[118:119], v4 offset:20992
    ds_read_b128 v[180:183], v6 offset:320
    ds_read_b64_tr_b16 v[120:121], v4 offset:24576
    ds_read_b64_tr_b16 v[122:123], v4 offset:25088
    ds_read_b128 v[184:187], v6 offset:384
    ds_read_b64_tr_b16 v[124:125], v4 offset:28672
    ds_read_b64_tr_b16 v[126:127], v4 offset:29184
    ds_read_b128 v[188:191], v6 offset:448
    ds_read_b64_tr_b16 v[128:129], v4 offset:32768
    ds_read_b64_tr_b16 v[130:131], v4 offset:33280
    ds_read_b128 v[192:195], v6 offset:512
    ds_read_b64_tr_b16 v[132:133], v4 offset:36864
    ds_read_b64_tr_b16 v[134:135], v4 offset:37376
    ds_read_b128 v[196:199], v6 offset:576
    ds_read_b64_tr_b16 v[136:137], v4 offset:40960
    ds_read_b64_tr_b16 v[138:139], v4 offset:41472
    ds_read_b128 v[200:203], v6 offset:640
    ds_read_b64_tr_b16 v[140:141], v4 offset:45056
    ds_read_b64_tr_b16 v[142:143], v4 offset:45568
    ds_read_b128 v[204:207], v6 offset:704
    ds_read_b64_tr_b16 v[144:145], v4 offset:49152
    ds_read_b64_tr_b16 v[146:147], v4 offset:49664
    ds_read_b128 v[208:211], v6 offset:768
    ds_read_b64_tr_b16 v[148:149], v4 offset:53248
    ds_read_b64_tr_b16 v[150:151], v4 offset:53760
    ds_read_b128 v[212:215], v6 offset:832
    ds_read_b64_tr_b16 v[152:153], v4 offset:57344
    ds_read_b64_tr_b16 v[154:155], v4 offset:57856
    ds_read_b128 v[216:219], v6 offset:896
    ds_read_b64_tr_b16 v[156:157], v4 offset:61440
    ds_read_b64_tr_b16 v[158:159], v4 offset:61952
    ds_read_b128 v[220:223], v6 offset:960
    s_waitcnt vmcnt(5)
    buffer_load_dwordx4 a[60:63], v2, s[32:35], s59 offen offset:3072 nt
    s_waitcnt lgkmcnt(0)
    v_mfma_f32_16x16x32_bf16 v[224:227], v[96:99], v[160:163], 0
    v_mfma_f32_16x16x32_bf16 v[228:231], v[100:103], v[164:167], 0
    v_mfma_f32_16x16x32_bf16 v[224:227], v[104:107], v[168:171], v[224:227]
    v_mfma_f32_16x16x32_bf16 v[228:231], v[108:111], v[172:175], v[228:231]
    v_mfma_f32_16x16x32_bf16 v[224:227], v[112:115], v[176:179], v[224:227]
    v_mfma_f32_16x16x32_bf16 v[228:231], v[116:119], v[180:183], v[228:231]
    v_mfma_f32_16x16x32_bf16 v[224:227], v[120:123], v[184:187], v[224:227]
    v_mfma_f32_16x16x32_bf16 v[228:231], v[124:127], v[188:191], v[228:231]
    v_mfma_f32_16x16x32_bf16 v[224:227], v[128:131], v[192:195], v[224:227]
    v_mfma_f32_16x16x32_bf16 v[228:231], v[132:135], v[196:199], v[228:231]
    v_mfma_f32_16x16x32_bf16 v[224:227], v[136:139], v[200:203], v[224:227]
    v_mfma_f32_16x16x32_bf16 v[228:231], v[140:143], v[204:207], v[228:231]
    v_mfma_f32_16x16x32_bf16 v[224:227], v[144:147], v[208:211], v[224:227]
    v_mfma_f32_16x16x32_bf16 v[228:231], v[148:151], v[212:215], v[228:231]
    v_mfma_f32_16x16x32_bf16 v[224:227], v[152:155], v[216:219], v[224:227]
    v_mfma_f32_16x16x32_bf16 v[228:231], v[156:159], v[220:223], v[228:231]
    s_mov_b32 s59, 65536
    s_waitcnt vmcnt(5)
    buffer_load_dwordx4 a[64:67], v2, s[32:35], s59 offen offset:0 nt
    v_mov_b32 v237, s58
    v_mov_b32 v239, s58
    s_nop 2
    v_add_f32 v224, v224, v228
    v_add_f32 v225, v225, v229
    v_add_f32 v226, v226, v230
    v_add_f32 v227, v227, v231
    s_cmp_lt_u32 s57, 16
    s_cbranch_scc0 L_h_epiH
    v_cvt_pk_bf16_f32 v236, v224, v225
    v_cvt_pk_bf16_f32 v238, v226, v227
    s_mov_b32 exec_lo, 0x00ff00ff
    s_mov_b32 exec_hi, 0x00ff00ff
    buffer_store_dwordx4 v[236:239], v13, s[48:51], 0 offen
    s_branch L_qh_pubH
L_h_epiH:
    s_waitcnt vmcnt(11)
    v_lshlrev_b32 v232, 16, v14
    v_and_b32 v233, 0xffff0000, v14
    v_lshlrev_b32 v234, 16, v15
    v_and_b32 v235, 0xffff0000, v15
    v_cvt_pk_bf16_f32 v224, v224, v224
    v_and_b32 v224, 0xffff0000, v224
    v_cvt_pk_bf16_f32 v225, v225, v225
    v_and_b32 v225, 0xffff0000, v225
    v_cvt_pk_bf16_f32 v226, v226, v226
    v_and_b32 v226, 0xffff0000, v226
    v_cvt_pk_bf16_f32 v227, v227, v227
    v_and_b32 v227, 0xffff0000, v227
    v_add_f32 v224, v224, v232
    v_add_f32 v225, v225, v233
    v_add_f32 v226, v226, v234
    v_add_f32 v227, v227, v235
    v_cvt_pk_bf16_f32 v224, v224, v224
    v_and_b32 v224, 0xffff0000, v224
    v_cvt_pk_bf16_f32 v225, v225, v225
    v_and_b32 v225, 0xffff0000, v225
    v_cvt_pk_bf16_f32 v226, v226, v226
    v_and_b32 v226, 0xffff0000, v226
    v_cvt_pk_bf16_f32 v227, v227, v227
    v_and_b32 v227, 0xffff0000, v227
    v_mul_f32 v232, v224, v224
    v_mul_f32 v233, v225, v225
    v_mul_f32 v234, v226, v226
    v_mul_f32 v235, v227, v227
    v_mov_b32 v236, 0xc0135761
    v_fmamk_f32 v232, v232, 0xbdd2d3e8, v236
    v_fmamk_f32 v233, v233, 0xbdd2d3e8, v236
    v_fmamk_f32 v234, v234, 0xbdd2d3e8, v236
    v_fmamk_f32 v235, v235, 0xbdd2d3e8, v236
    v_mul_f32 v232, v232, v224
    v_mul_f32 v233, v233, v225
    v_mul_f32 v234, v234, v226
    v_mul_f32 v235, v235, v227
    v_exp_f32 v232, v232
    v_exp_f32 v233, v233
    v_exp_f32 v234, v234
    v_exp_f32 v235, v235
    v_add_f32 v232, 1.0, v232
    v_add_f32 v233, 1.0, v233
    v_add_f32 v234, 1.0, v234
    v_add_f32 v235, 1.0, v235
    v_rcp_f32 v232, v232
    v_rcp_f32 v233, v233
    v_rcp_f32 v234, v234
    v_rcp_f32 v235, v235
    v_mul_f32 v224, v224, v232
    v_mul_f32 v225, v225, v233
    v_mul_f32 v226, v226, v234
    v_mul_f32 v227, v227, v235
    v_cvt_pk_bf16_f32 v236, v224, v225
    v_cvt_pk_bf16_f32 v238, v226, v227
    s_mov_b32 exec_lo, 0x00ff00ff
    s_mov_b32 exec_hi, 0x00ff00ff
    buffer_store_dwordx4 v[236:239], v13, s[48:51], 0 offen sc1
L_qh_pubH:
    s_mov_b64 exec, -1
L_qh_doneH:
    s_waitcnt vmcnt(5)
    buffer_load_dwordx4 a[68:71], v2, s[32:35], s59 offen offset:1024 nt
    s_waitcnt vmcnt(5)
    buffer_load_dwordx4 a[72:75], v2, s[32:35], s59 offen offset:2048 nt
    s_waitcnt vmcnt(5)
    buffer_load_dwordx4 a[76:79], v2, s[32:35], s59 offen offset:3072 nt
    s_mov_b32 s59, 81920
    s_waitcnt vmcnt(5)
    buffer_load_dwordx4 a[80:83], v2, s[32:35], s59 offen offset:0 nt
    s_waitcnt vmcnt(5)
    buffer_load_dwordx4 a[84:87], v2, s[32:35], s59 offen offset:1024 nt
    s_waitcnt vmcnt(5)
    buffer_load_dwordx4 a[88:91], v2, s[32:35], s59 offen offset:2048 nt
    s_waitcnt vmcnt(5)
    buffer_load_dwordx4 a[92:95], v2, s[32:35], s59 offen offset:3072 nt
    s_mov_b32 s59, 98304
    s_waitcnt vmcnt(5)
    buffer_load_dwordx4 a[96:99], v2, s[32:35], s59 offen offset:0 nt
    s_waitcnt vmcnt(5)
    buffer_load_dwordx4 a[100:103], v2, s[32:35], s59 offen offset:1024 nt
    s_waitcnt vmcnt(5)
    buffer_load_dwordx4 a[104:107], v2, s[32:35], s59 offen offset:2048 nt
    s_waitcnt vmcnt(5)
    buffer_load_dwordx4 a[108:111], v2, s[32:35], s59 offen offset:3072 nt
    s_mov_b32 s59, 114688
    s_waitcnt vmcnt(5)
    buffer_load_dwordx4 a[112:115], v2, s[32:35], s59 offen offset:0 nt
    s_waitcnt vmcnt(5)
    buffer_load_dwordx4 a[116:119], v2, s[32:35], s59 offen offset:1024 nt
    s_waitcnt vmcnt(5)
    buffer_load_dwordx4 a[120:123], v2, s[32:35], s59 offen offset:2048 nt
    s_waitcnt vmcnt(5)
    buffer_load_dwordx4 a[124:127], v2, s[32:35], s59 offen offset:3072 nt
    s_mov_b32 s59, 131072
    s_waitcnt vmcnt(6)
    buffer_load_dwordx4 a[128:131], v2, s[32:35], s59 offen offset:0 nt
    s_waitcnt vmcnt(6)
    buffer_load_dwordx4 a[132:135], v2, s[32:35], s59 offen offset:1024 nt
    s_waitcnt vmcnt(6)
    buffer_load_dwordx4 a[136:139], v2, s[32:35], s59 offen offset:2048 nt
    s_waitcnt vmcnt(6)
    buffer_load_dwordx4 a[140:143], v2, s[32:35], s59 offen offset:3072 nt
    s_mov_b32 s59, 147456
    s_waitcnt vmcnt(6)
    buffer_load_dwordx4 a[144:147], v2, s[32:35], s59 offen offset:0 nt
    s_waitcnt vmcnt(6)
    buffer_load_dwordx4 a[148:151], v2, s[32:35], s59 offen offset:1024 nt
    s_waitcnt vmcnt(6)
    buffer_load_dwordx4 a[152:155], v2, s[32:35], s59 offen offset:2048 nt
    s_waitcnt vmcnt(6)
    buffer_load_dwordx4 a[156:159], v2, s[32:35], s59 offen offset:3072 nt
    s_mov_b32 s59, 163840
    s_waitcnt vmcnt(6)
    buffer_load_dwordx4 a[160:163], v2, s[32:35], s59 offen offset:0 nt
    s_waitcnt vmcnt(6)
    buffer_load_dwordx4 a[164:167], v2, s[32:35], s59 offen offset:1024 nt
    s_waitcnt vmcnt(6)
    buffer_load_dwordx4 a[168:171], v2, s[32:35], s59 offen offset:2048 nt
    s_waitcnt vmcnt(6)
    buffer_load_dwordx4 a[172:175], v2, s[32:35], s59 offen offset:3072 nt
    s_lshl_b32 s61, s54, 14
    s_lshl_b32 s62, s53, 11
    s_add_u32 s61, s61, s62
    s_add_u32 s61, s61, 65536
    v_bfe_u32 v15, v1, 2, 2
    v_lshlrev_b32 v15, 9, v15
    v_lshrrev_b32 v6, 4, v1
    v_lshl_add_u32 v15, v6, 7, v15
    v_and_b32 v7, 3, v1
    v_lshl_add_u32 v15, v7, 5, v15
    v_add_u32 v15, s61, v15
    s_mov_b32 s59, 180224
    s_waitcnt vmcnt(6)
    buffer_load_dwordx4 a[176:179], v2, s[32:35], s59 offen offset:0 nt
    s_waitcnt vmcnt(6)
    buffer_load_dwordx4 a[180:183], v2, s[32:35], s59 offen offset:1024 nt
    s_waitcnt vmcnt(6)
    buffer_load_dwordx4 a[184:187], v2, s[32:35], s59 offen offset:2048 nt
    s_waitcnt vmcnt(6)
    buffer_load_dwordx4 a[188:191], v2, s[32:35], s59 offen offset:3072 nt
    s_mov_b32 s59, 196608
    s_waitcnt vmcnt(6)
    buffer_load_dwordx4 a[192:195], v2, s[32:35], s59 offen offset:0 nt
    s_waitcnt vmcnt(6)
    buffer_load_dwordx4 a[196:199], v2, s[32:35], s59 offen offset:1024 nt
    s_waitcnt vmcnt(6)
    buffer_load_dwordx4 a[200:203], v2, s[32:35], s59 offen offset:2048 nt
    s_waitcnt vmcnt(6)
    buffer_load_dwordx4 a[204:207], v2, s[32:35], s59 offen offset:3072 nt
    s_mov_b32 s59, 212992
    s_waitcnt vmcnt(6)
    buffer_load_dwordx4 a[208:211], v2, s[32:35], s59 offen offset:0 nt
    s_waitcnt vmcnt(6)
    buffer_load_dwordx4 a[212:215], v2, s[32:35], s59 offen offset:1024 nt
    s_waitcnt vmcnt(6)
    buffer_load_dwordx4 a[216:219], v2, s[32:35], s59 offen offset:2048 nt
    s_waitcnt vmcnt(6)
    buffer_load_dwordx4 a[220:223], v2, s[32:35], s59 offen offset:3072 nt
    s_mov_b32 s59, 229376
    s_waitcnt vmcnt(6)
    buffer_load_dwordx4 a[224:227], v2, s[32:35], s59 offen offset:0 nt
    s_waitcnt vmcnt(6)
    buffer_load_dwordx4 a[228:231], v2, s[32:35], s59 offen offset:1024 nt
    s_waitcnt vmcnt(6)
    buffer_load_dwordx4 a[232:235], v2, s[32:35], s59 offen offset:2048 nt
    s_waitcnt vmcnt(6)
    buffer_load_dwordx4 a[236:239], v2, s[32:35], s59 offen offset:3072 nt
    s_mov_b32 s59, 245760
    s_waitcnt vmcnt(6)
    buffer_load_dwordx4 a[240:243], v2, s[32:35], s59 offen offset:0 nt
    s_waitcnt vmcnt(6)
    buffer_load_dwordx4 a[244:247], v2, s[32:35], s59 offen offset:1024 nt
    s_waitcnt vmcnt(6)
    buffer_load_dwordx4 a[248:251], v2, s[32:35], s59 offen offset:2048 nt
    s_waitcnt vmcnt(6)
    buffer_load_dwordx4 a[252:255], v2, s[32:35], s59 offen offset:3072 nt
    buffer_load_dwordx4 v[80:83], v15, s[48:51], 0 offen sc1
    buffer_load_dwordx4 v[84:87], v15, s[48:51], 0 offen offset:16 sc1
    s_mov_b32 s59, 0
    s_waitcnt vmcnt(8)
    buffer_load_dwordx4 v[96:99], v3, s[36:39], s59 offen offset:0 nt
    s_waitcnt vmcnt(8)
    buffer_load_dwordx4 v[100:103], v3, s[36:39], s59 offen offset:1024 nt
    s_waitcnt vmcnt(8)
    buffer_load_dwordx4 v[104:107], v3, s[36:39], s59 offen offset:2048 nt
    s_waitcnt vmcnt(8)
    buffer_load_dwordx4 v[108:111], v3, s[36:39], s59 offen offset:3072 nt
    s_mov_b32 s59, 16384
    s_waitcnt vmcnt(8)
    buffer_load_dwordx4 v[112:115], v3, s[36:39], s59 offen offset:0 nt
    s_waitcnt vmcnt(8)
    buffer_load_dwordx4 v[116:119], v3, s[36:39], s59 offen offset:1024 nt
    s_waitcnt vmcnt(8)
    buffer_load_dwordx4 v[120:123], v3, s[36:39], s59 offen offset:2048 nt
    s_waitcnt vmcnt(6)
    buffer_load_dwordx4 v[124:127], v3, s[36:39], s59 offen offset:3072 nt
    s_mov_b32 s59, 32768
    s_waitcnt vmcnt(6)
    buffer_load_dwordx4 v[128:131], v3, s[36:39], s59 offen offset:0 nt
    s_waitcnt vmcnt(6)
    buffer_load_dwordx4 v[132:135], v3, s[36:39], s59 offen offset:1024 nt
    s_waitcnt vmcnt(6)
    buffer_load_dwordx4 v[136:139], v3, s[36:39], s59 offen offset:2048 nt
    s_waitcnt vmcnt(6)
    buffer_load_dwordx4 v[140:143], v3, s[36:39], s59 offen offset:3072 nt
    s_mov_b32 s59, 49152
    s_waitcnt vmcnt(6)
    buffer_load_dwordx4 v[144:147], v3, s[36:39], s59 offen offset:0 nt
    s_waitcnt vmcnt(6)
    buffer_load_dwordx4 v[148:151], v3, s[36:39], s59 offen offset:1024 nt
    s_waitcnt vmcnt(6)
    buffer_load_dwordx4 v[152:155], v3, s[36:39], s59 offen offset:2048 nt
    s_waitcnt vmcnt(6)
    buffer_load_dwordx4 v[156:159], v3, s[36:39], s59 offen offset:3072 nt
    s_branch L_join
L_pathW:
    s_waitcnt lgkmcnt(0)
    s_mov_b32 s32, s6
    s_mov_b32 s33, s7
    s_mov_b32 s59, 16384
    buffer_load_dwordx4 a[16:19], v2, s[32:35], s59 offen offset:0 nt
    s_waitcnt vmcnt(4)
    buffer_load_dwordx4 a[20:23], v2, s[32:35], s59 offen offset:1024 nt
    s_load_dword s58, s[30:31], 0
    s_mov_b32 s36, s8
    s_mov_b32 s37, s9
    s_mov_b32 s38, 0x4000000
    s_mov_b32 s39, 0x20000
    s_mov_b32 s48, s30
    s_mov_b32 s49, s31
    s_mov_b32 s50, 0x10000000
    s_mov_b32 s51, 0x20000
    s_mov_b32 s64, 0x22222222
    s_mov_b32 s65, 0x22222222
    s_mov_b32 s66, 0x44444444
    s_mov_b32 s67, 0x44444444
    s_mov_b32 s68, 0x88888888
    s_mov_b32 s69, 0x88888888
    s_mov_b32 s70, 0x05040100
    s_mov_b32 s71, 0x07060302
    s_mov_b32 s72, 0x3fb8aa3b
    s_mov_b32 s73, 1048576
    s_getreg_b32 s56, hwreg(HW_REG_XCC_ID, 0, 4)
    s_mov_b32 s44, s12
    s_mov_b32 s45, s13
    s_mov_b32 s46, 4194304
    s_mov_b32 s47, 0x20000
    s_lshl_b32 s77, s53, 5
    s_add_u32 s77, s77, s57
    s_lshl_b32 s61, s77, 10
    s_lshl_b32 s62, s52, 8
    s_add_u32 s61, s61, s62
    s_add_u32 s61, s61, 327680
    v_lshl_add_u32 v8, v1, 2, s61
    s_lshl_b32 s61, s53, 2
    s_add_u32 s78, s61, s55
    s_lshr_b32 s61, s55, 1
    s_lshl_b32 s61, s61, 5
    s_and_b32 s62, s55, 1
    s_lshl_b32 s62, s62, 3
    s_add_u32 s79, s61, s62
    v_and_b32 v12, 3, v1
    v_lshlrev_b32 v12, 1, v12
    v_and_b32 v5, 16, v1
    v_add_u32 v12, v12, v5
    v_lshrrev_b32 v5, 5, v1
    v_add3_u32 v12, v12, v5, s79
    v_mov_b32 v5, -1
    buffer_store_dword v5, v8, s[48:51], 0 offen
    s_waitcnt vmcnt(5)
    buffer_load_dwordx4 a[24:27], v2, s[32:35], s59 offen offset:2048 nt
    s_waitcnt vmcnt(5)
    buffer_load_dwordx4 a[28:31], v2, s[32:35], s59 offen offset:3072 nt
    s_mov_b32 s59, 32768
    s_waitcnt vmcnt(5)
    buffer_load_dwordx4 a[32:35], v2, s[32:35], s59 offen offset:0 nt
    s_waitcnt vmcnt(5)
    buffer_load_dwordx4 a[36:39], v2, s[32:35], s59 offen offset:1024 nt
    s_waitcnt vmcnt(5)
    buffer_load_dwordx4 a[40:43], v2, s[32:35], s59 offen offset:2048 nt
    s_waitcnt vmcnt(4)
    buffer_load_dwordx4 a[44:47], v2, s[32:35], s59 offen offset:3072 nt
    s_mov_b32 s59, 49152
    s_waitcnt vmcnt(4)
    buffer_load_dwordx4 a[48:51], v2, s[32:35], s59 offen offset:0 nt
    s_waitcnt vmcnt(4)
    buffer_load_dwordx4 a[52:55], v2, s[32:35], s59 offen offset:1024 nt
    s_waitcnt vmcnt(4)
    buffer_load_dwordx4 a[56:59], v2, s[32:35], s59 offen offset:2048 nt
    s_waitcnt vmcnt(4)
    buffer_load_dwordx4 a[60:63], v2, s[32:35], s59 offen offset:3072 nt
    s_mov_b32 s59, 65536
    s_waitcnt vmcnt(4)
    buffer_load_dwordx4 a[64:67], v2, s[32:35], s59 offen offset:0 nt
    s_waitcnt vmcnt(4)
    buffer_load_dwordx4 a[68:71], v2, s[32:35], s59 offen offset:1024 nt
    s_mov_b32 s40, s20
    s_mov_b32 s41, s21
    s_mov_b32 s42, 1835008
    s_mov_b32 s43, 0x20000
    v_lshrrev_b32 v5, 3, v1
    s_lshl_b32 s61, s52, 6
    v_add_u32 v5, s61, v5
    v_lshlrev_b32 v5, 10, v5
    v_and_b32 v4, 7, v1
    v_bfe_u32 v6, v1, 4, 1
    v_lshlrev_b32 v6, 1, v6
    v_xor_b32 v4, v4, v6
    v_lshl_add_u32 v5, v4, 4, v5
    v_xor_b32 v6, 64, v5
    s_sub_u32 s76, s57, 16
    s_lshl_b32 s61, s76, 18
    s_lshl_b32 s62, s53, 7
    s_add_u32 s61, s61, s62
    s_lshl_b32 s63, s52, 13
    s_add_u32 m0, s63, 0
    s_nop 0
    buffer_load_dwordx4 v5, s[40:43], s61 offen nt lds
    s_add_u32 s61, s61, 8192
    s_add_u32 m0, s63, 1024
    s_nop 0
    buffer_load_dwordx4 v6, s[40:43], s61 offen nt lds
    s_add_u32 s61, s61, 8192
    s_add_u32 m0, s63, 2048
    s_nop 0
    buffer_load_dwordx4 v5, s[40:43], s61 offen nt lds
    s_add_u32 s61, s61, 8192
    s_add_u32 m0, s63, 3072
    s_nop 0
    buffer_load_dwordx4 v6, s[40:43], s61 offen nt lds
    s_add_u32 s61, s61, 8192
    s_add_u32 m0, s63, 4096
    s_nop 0
    buffer_load_dwordx4 v5, s[40:43], s61 offen nt lds
    s_add_u32 s61, s61, 8192
    s_add_u32 m0, s63, 5120
    s_nop 0
    buffer_load_dwordx4 v6, s[40:43], s61 offen nt lds
    s_add_u32 s61, s61, 8192
    s_add_u32 m0, s63, 6144
    s_nop 0
    buffer_load_dwordx4 v5, s[40:43], s61 offen nt lds
    s_add_u32 s61, s61, 8192
    s_add_u32 m0, s63, 7168
    s_nop 0
    buffer_load_dwordx4 v6, s[40:43], s61 offen nt lds
    v_lshrrev_b32 v4, 4, v1
    v_lshlrev_b32 v4, 3, v4
    v_bfe_u32 v5, v1, 2, 2
    v_add_u32 v4, v4, v5
    v_lshlrev_b32 v4, 7, v4
    v_and_b32 v5, 3, v1
    v_lshl_add_u32 v4, v5, 3, v4
    v_bfe_u32 v5, v1, 3, 2
    v_xor_b32 v5, s52, v5
    v_lshl_add_u32 v4, v5, 5, v4
    s_waitcnt vmcnt(12)
    buffer_load_dwordx4 a[72:75], v2, s[32:35], s59 offen offset:2048 nt
    s_waitcnt vmcnt(12)
    buffer_load_dwordx4 a[76:79], v2, s[32:35], s59 offen offset:3072 nt
    s_mov_b32 s59, 81920
    s_waitcnt vmcnt(12)
    buffer_load_dwordx4 a[80:83], v2, s[32:35], s59 offen offset:0 nt
    s_waitcnt vmcnt(12)
    buffer_load_dwordx4 a[84:87], v2, s[32:35], s59 offen offset:1024 nt
    s_waitcnt vmcnt(12)
    buffer_load_dwordx4 a[88:91], v2, s[32:35], s59 offen offset:2048 nt
    s_waitcnt vmcnt(4)
    buffer_load_dwordx4 a[92:95], v2, s[32:35], s59 offen offset:3072 nt
    s_waitcnt lgkmcnt(0)
    s_add_u32 s58, s58, 1
    s_mov_b32 s59, 98304
    s_waitcnt vmcnt(4)
    buffer_load_dwordx4 a[96:99], v2, s[32:35], s59 offen offset:0 nt
    s_waitcnt vmcnt(4)
    buffer_load_dwordx4 a[100:103], v2, s[32:35], s59 offen offset:1024 nt
    s_waitcnt vmcnt(4)
    buffer_load_dwordx4 a[104:107], v2, s[32:35], s59 offen offset:2048 nt
    s_waitcnt vmcnt(4)
    buffer_load_dwordx4 a[108:111], v2, s[32:35], s59 offen offset:3072 nt
    s_mov_b32 s59, 114688
    s_waitcnt vmcnt(4)
    buffer_load_dwordx4 a[112:115], v2, s[32:35], s59 offen offset:0 nt
    s_waitcnt vmcnt(4)
    buffer_load_dwordx4 a[116:119], v2, s[32:35], s59 offen offset:1024 nt
    s_waitcnt vmcnt(4)
    buffer_load_dwordx4 a[120:123], v2, s[32:35], s59 offen offset:2048 nt
    s_waitcnt vmcnt(4)
    buffer_load_dwordx4 a[124:127], v2, s[32:35], s59 offen offset:3072 nt
    s_mov_b32 s59, 131072
    s_waitcnt vmcnt(5)
    buffer_load_dwordx4 a[128:131], v2, s[32:35], s59 offen offset:0 nt
    s_waitcnt vmcnt(5)
    buffer_load_dwordx4 a[132:135], v2, s[32:35], s59 offen offset:1024 nt
    s_waitcnt vmcnt(5)
    buffer_load_dwordx4 a[136:139], v2, s[32:35], s59 offen offset:2048 nt
    s_waitcnt vmcnt(5)
    buffer_load_dwordx4 a[140:143], v2, s[32:35], s59 offen offset:3072 nt
    s_mov_b32 s59, 147456
    s_waitcnt vmcnt(5)
    buffer_load_dwordx4 a[144:147], v2, s[32:35], s59 offen offset:0 nt
    s_waitcnt vmcnt(5)
    buffer_load_dwordx4 a[148:151], v2, s[32:35], s59 offen offset:1024 nt
    s_waitcnt vmcnt(5)
    buffer_load_dwordx4 a[152:155], v2, s[32:35], s59 offen offset:2048 nt
    s_waitcnt vmcnt(5)
    buffer_load_dwordx4 a[156:159], v2, s[32:35], s59 offen offset:3072 nt
    s_mov_b32 s59, 163840
    s_waitcnt vmcnt(5)
    buffer_load_dwordx4 a[160:163], v2, s[32:35], s59 offen offset:0 nt
    s_waitcnt vmcnt(5)
    buffer_load_dwordx4 a[164:167], v2, s[32:35], s59 offen offset:1024 nt
    s_waitcnt vmcnt(5)
    buffer_load_dwordx4 a[168:171], v2, s[32:35], s59 offen offset:2048 nt
    s_waitcnt vmcnt(5)
    buffer_load_dwordx4 a[172:175], v2, s[32:35], s59 offen offset:3072 nt
    s_lshl_b32 s61, s54, 14
    s_lshl_b32 s62, s53, 11
    s_add_u32 s61, s61, s62
    s_add_u32 s61, s61, 65536
    v_bfe_u32 v15, v1, 2, 2
    v_lshlrev_b32 v15, 9, v15
    v_lshrrev_b32 v6, 4, v1
    v_lshl_add_u32 v15, v6, 7, v15
    v_and_b32 v7, 3, v1
    v_lshl_add_u32 v15, v7, 5, v15
    v_add_u32 v15, s61, v15
    s_mov_b32 s59, 180224
    s_waitcnt vmcnt(5)
    buffer_load_dwordx4 a[176:179], v2, s[32:35], s59 offen offset:0 nt
    s_waitcnt vmcnt(5)
    buffer_load_dwordx4 a[180:183], v2, s[32:35], s59 offen offset:1024 nt
    s_waitcnt vmcnt(5)
    buffer_load_dwordx4 a[184:187], v2, s[32:35], s59 offen offset:2048 nt
    s_waitcnt vmcnt(5)
    buffer_load_dwordx4 a[188:191], v2, s[32:35], s59 offen offset:3072 nt
    s_mov_b32 s59, 196608
    s_waitcnt vmcnt(5)
    buffer_load_dwordx4 a[192:195], v2, s[32:35], s59 offen offset:0 nt
    s_waitcnt vmcnt(5)
    buffer_load_dwordx4 a[196:199], v2, s[32:35], s59 offen offset:1024 nt
    s_waitcnt vmcnt(5)
    buffer_load_dwordx4 a[200:203], v2, s[32:35], s59 offen offset:2048 nt
    s_waitcnt vmcnt(5)
    buffer_load_dwordx4 a[204:207], v2, s[32:35], s59 offen offset:3072 nt
    s_mov_b32 s59, 212992
    s_waitcnt vmcnt(5)
    buffer_load_dwordx4 a[208:211], v2, s[32:35], s59 offen offset:0 nt
    s_waitcnt vmcnt(5)
    buffer_load_dwordx4 a[212:215], v2, s[32:35], s59 offen offset:1024 nt
    s_waitcnt vmcnt(5)
    buffer_load_dwordx4 a[216:219], v2, s[32:35], s59 offen offset:2048 nt
    s_waitcnt vmcnt(5)
    buffer_load_dwordx4 a[220:223], v2, s[32:35], s59 offen offset:3072 nt
    s_lshl_b32 s61, s76, 10
    s_lshl_b32 s62, s52, 8
    s_add_u32 s61, s61, s62
    s_add_u32 s61, s61, 196608
    v_and_b32 v7, 7, v1
    v_mul_u32_u24 v7, 7168, v7
    v_lshl_add_u32 v7, v6, 5, v7
    v_add_u32 v7, s61, v7
    buffer_load_dwordx4 v[16:19], v7, s[48:51], 0 offen offset:0 sc1
    buffer_load_dwordx4 v[20:23], v7, s[48:51], 0 offen offset:16 sc1
    buffer_load_dwordx4 v[24:27], v7, s[48:51], 0 offen offset:128 sc1
    buffer_load_dwordx4 v[28:31], v7, s[48:51], 0 offen offset:144 sc1
    s_lshl_b32 s61, s52, 11
    s_add_u32 s61, s61, 32768
    v_lshl_add_u32 v5, v1, 4, s61
    v_lshlrev_b32 v13, 4, v1
    s_mov_b32 s59, 229376
    s_waitcnt vmcnt(9)
    buffer_load_dwordx4 a[224:227], v2, s[32:35], s59 offen offset:0 nt
    s_waitcnt vmcnt(9)
    buffer_load_dwordx4 a[228:231], v2, s[32:35], s59 offen offset:1024 nt
    s_waitcnt vmcnt(9)
    buffer_load_dwordx4 a[232:235], v2, s[32:35], s59 offen offset:2048 nt
    s_waitcnt vmcnt(9)
    buffer_load_dwordx4 a[236:239], v2, s[32:35], s59 offen offset:3072 nt
    s_mov_b32 s59, 245760
    s_waitcnt vmcnt(9)
    buffer_load_dwordx4 a[240:243], v2, s[32:35], s59 offen offset:0 nt
    s_waitcnt vmcnt(9)
    buffer_load_dwordx4 a[244:247], v2, s[32:35], s59 offen offset:1024 nt
    s_waitcnt vmcnt(5)
    buffer_load_dwordx4 a[248:251], v2, s[32:35], s59 offen offset:2048 nt
    s_waitcnt vmcnt(5)
    buffer_load_dwordx4 a[252:255], v2, s[32:35], s59 offen offset:3072 nt
    buffer_load_dwordx4 v[80:83], v15, s[48:51], 0 offen sc1
    buffer_load_dwordx4 v[84:87], v15, s[48:51], 0 offen offset:16 sc1
    s_waitcnt vmcnt(10)
L_h_chk:
    v_xor_b32 v14, s58, v17
    v_bitop3_b32 v14, v14, v19, s58 bitop3:0xf6
    v_bitop3_b32 v14, v14, v21, s58 bitop3:0xf6
    v_bitop3_b32 v14, v14, v23, s58 bitop3:0xf6
    v_bitop3_b32 v14, v14, v25, s58 bitop3:0xf6
    v_bitop3_b32 v14, v14, v27, s58 bitop3:0xf6
    v_bitop3_b32 v14, v14, v29, s58 bitop3:0xf6
    v_bitop3_b32 v14, v14, v31, s58 bitop3:0xf6
    v_cmp_ne_u32 vcc, 0, v14
    s_nop 0
    s_cbranch_vccz L_h_ok
    s_cmp_eq_u32 s73, 0
    s_cbranch_scc1 L_h_ok
    s_sub_u32 s73, s73, 1
    s_mov_b64 exec, vcc
    buffer_load_dwordx4 v[16:19], v7, s[48:51], 0 offen offset:0 sc1
    buffer_load_dwordx4 v[20:23], v7, s[48:51], 0 offen offset:16 sc1
    buffer_load_dwordx4 v[24:27], v7, s[48:51], 0 offen offset:128 sc1
    buffer_load_dwordx4 v[28:31], v7, s[48:51], 0 offen offset:144 sc1
    s_mov_b64 exec, -1
    s_waitcnt vmcnt(0)
    s_branch L_h_chk
L_h_ok:
    v_mov_b32 v17, v18
    v_mov_b32 v18, v20
    v_mov_b32 v19, v22
    v_mov_b32 v20, v24
    v_mov_b32 v21, v26
    v_mov_b32 v22, v28
    v_mov_b32 v23, v30
    ds_write_b128 v5, v[16:19]
    ds_write_b128 v5, v[20:23] offset:1024
    s_mov_b32 s59, 0
    s_waitcnt vmcnt(7)
    buffer_load_dwordx4 v[96:99], v3, s[36:39], s59 offen offset:0 nt
    s_waitcnt lgkmcnt(0)
    s_barrier
    ds_read_b64_tr_b16 v[192:193], v4 offset:0
    ds_read_b64_tr_b16 v[194:195], v4 offset:512
    ds_read_b128 v[224:227], v13 offset:32768
    ds_read_b64_tr_b16 v[196:197], v4 offset:4096
    ds_read_b64_tr_b16 v[198:199], v4 offset:4608
    ds_read_b128 v[228:231], v13 offset:33792
    ds_read_b64_tr_b16 v[200:201], v4 offset:8192
    ds_read_b64_tr_b16 v[202:203], v4 offset:8704
    ds_read_b128 v[232:235], v13 offset:34816
    ds_read_b64_tr_b16 v[204:205], v4 offset:12288
    ds_read_b64_tr_b16 v[206:207], v4 offset:12800
    ds_read_b128 v[236:239], v13 offset:35840
    ds_read_b64_tr_b16 v[208:209], v4 offset:16384
    ds_read_b64_tr_b16 v[210:211], v4 offset:16896
    ds_read_b128 v[240:243], v13 offset:36864
    ds_read_b64_tr_b16 v[212:213], v4 offset:20480
    ds_read_b64_tr_b16 v[214:215], v4 offset:20992
    ds_read_b128 v[244:247], v13 offset:37888
    ds_read_b64_tr_b16 v[216:217], v4 offset:24576
    ds_read_b64_tr_b16 v[218:219], v4 offset:25088
    ds_read_b128 v[248:251], v13 offset:38912
    ds_read_b64_tr_b16 v[220:221], v4 offset:28672
    ds_read_b64_tr_b16 v[222:223], v4 offset:29184
    ds_read_b128 v[252:255], v13 offset:39936
    s_lshl_b32 s61, s53, 15
    s_lshl_b32 s62, s76, 12
    s_add_u32 s61, s61, s62
    s_lshl_b32 s62, s52, 7
    s_add_u32 s61, s61, s62
    s_add_u32 s61, s61, 589824
    v_and_b32 v7, 7, v1
    v_lshlrev_b32 v7, 9, v7
    v_lshl_add_u32 v7, v6, 5, v7
    v_add_u32 v7, s61, v7
    v_mov_b32 v89, s58
    v_mov_b32 v91, s58
    v_mov_b32 v93, s58
    v_mov_b32 v95, s58
    s_waitcnt vmcnt(7)
    buffer_load_dwordx4 v[100:103], v3, s[36:39], s59 offen offset:1024 nt
    s_waitcnt lgkmcnt(0)
    v_mfma_f32_16x16x32_bf16 v[16:19], v[192:195], v[224:227], 0
    v_mfma_f32_16x16x32_bf16 v[16:19], v[196:199], v[228:231], v[16:19]
    v_mfma_f32_16x16x32_bf16 v[16:19], v[200:203], v[232:235], v[16:19]
    v_mfma_f32_16x16x32_bf16 v[16:19], v[204:207], v[236:239], v[16:19]
    v_mfma_f32_16x16x32_bf16 v[16:19], v[208:211], v[240:243], v[16:19]
    v_mfma_f32_16x16x32_bf16 v[16:19], v[212:215], v[244:247], v[16:19]
    v_mfma_f32_16x16x32_bf16 v[16:19], v[216:219], v[248:251], v[16:19]
    v_mfma_f32_16x16x32_bf16 v[16:19], v[220:223], v[252:255], v[16:19]
    s_waitcnt vmcnt(7)
    buffer_load_dwordx4 v[104:107], v3, s[36:39], s59 offen offset:2048 nt
    s_nop 5
    v_mov_b32 v88, v16
    v_mov_b32 v90, v17
    v_mov_b32 v92, v18
    v_mov_b32 v94, v19
    s_mov_b32 exec_lo, 0x00ff00ff
    s_mov_b32 exec_hi, 0x00ff00ff
    buffer_store_dwordx4 v[88:91], v7, s[48:51], 0 offen
    buffer_store_dwordx4 v[92:95], v7, s[48:51], 0 offen offset:16
    s_mov_b64 exec, -1
    s_waitcnt vmcnt(9)
    buffer_load_dwordx4 v[108:111], v3, s[36:39], s59 offen offset:3072 nt
    s_mov_b32 s59, 16384
    s_waitcnt vmcnt(9)
    buffer_load_dwordx4 v[112:115], v3, s[36:39], s59 offen offset:0 nt
    s_waitcnt vmcnt(9)
    buffer_load_dwordx4 v[116:119], v3, s[36:39], s59 offen offset:1024 nt
    s_waitcnt vmcnt(7)
    buffer_load_dwordx4 v[120:123], v3, s[36:39], s59 offen offset:2048 nt
    s_waitcnt vmcnt(7)
    buffer_load_dwordx4 v[124:127], v3, s[36:39], s59 offen offset:3072 nt
    s_mov_b32 s59, 32768
    s_waitcnt vmcnt(7)
    buffer_load_dwordx4 v[128:131], v3, s[36:39], s59 offen offset:0 nt
    s_waitcnt vmcnt(5)
    buffer_load_dwordx4 v[132:135], v3, s[36:39], s59 offen offset:1024 nt
    s_waitcnt vmcnt(5)
    buffer_load_dwordx4 v[136:139], v3, s[36:39], s59 offen offset:2048 nt
    s_waitcnt vmcnt(5)
    buffer_load_dwordx4 v[140:143], v3, s[36:39], s59 offen offset:3072 nt
    s_mov_b32 s59, 49152
    s_waitcnt vmcnt(5)
    buffer_load_dwordx4 v[144:147], v3, s[36:39], s59 offen offset:0 nt
    s_waitcnt vmcnt(5)
    buffer_load_dwordx4 v[148:151], v3, s[36:39], s59 offen offset:1024 nt
    s_waitcnt vmcnt(5)
    buffer_load_dwordx4 v[152:155], v3, s[36:39], s59 offen offset:2048 nt
    s_waitcnt vmcnt(5)
    buffer_load_dwordx4 v[156:159], v3, s[36:39], s59 offen offset:3072 nt
    s_branch L_join
L_pathN:
    s_waitcnt lgkmcnt(0)
    s_mov_b32 s32, s6
    s_mov_b32 s33, s7
    s_mov_b32 s59, 16384
    buffer_load_dwordx4 a[16:19], v2, s[32:35], s59 offen offset:0 nt
    s_waitcnt vmcnt(4)
    buffer_load_dwordx4 a[20:23], v2, s[32:35], s59 offen offset:1024 nt
    s_load_dword s58, s[30:31], 0
    s_mov_b32 s36, s8
    s_mov_b32 s37, s9
    s_mov_b32 s38, 0x4000000
    s_mov_b32 s39, 0x20000
    s_mov_b32 s48, s30
    s_mov_b32 s49, s31
    s_mov_b32 s50, 0x10000000
    s_mov_b32 s51, 0x20000
    s_mov_b32 s64, 0x22222222
    s_mov_b32 s65, 0x22222222
    s_mov_b32 s66, 0x44444444
    s_mov_b32 s67, 0x44444444
    s_mov_b32 s68, 0x88888888
    s_mov_b32 s69, 0x88888888
    s_mov_b32 s70, 0x05040100
    s_mov_b32 s71, 0x07060302
    s_mov_b32 s72, 0x3fb8aa3b
    s_mov_b32 s73, 1048576
    s_getreg_b32 s56, hwreg(HW_REG_XCC_ID, 0, 4)
    s_mov_b32 s44, s12
    s_mov_b32 s45, s13
    s_mov_b32 s46, 4194304
    s_mov_b32 s47, 0x20000
    s_lshl_b32 s77, s53, 5
    s_add_u32 s77, s77, s57
    s_lshl_b32 s61, s77, 10
    s_lshl_b32 s62, s52, 8
    s_add_u32 s61, s61, s62
    s_add_u32 s61, s61, 327680
    v_lshl_add_u32 v8, v1, 2, s61
    s_lshl_b32 s61, s53, 2
    s_add_u32 s78, s61, s55
    s_lshr_b32 s61, s55, 1
    s_lshl_b32 s61, s61, 5
    s_and_b32 s62, s55, 1
    s_lshl_b32 s62, s62, 3
    s_add_u32 s79, s61, s62
    v_and_b32 v12, 3, v1
    v_lshlrev_b32 v12, 1, v12
    v_and_b32 v5, 16, v1
    v_add_u32 v12, v12, v5
    v_lshrrev_b32 v5, 5, v1
    v_add3_u32 v12, v12, v5, s79
    v_mov_b32 v5, -1
    buffer_store_dword v5, v8, s[48:51], 0 offen
    s_waitcnt vmcnt(5)
    buffer_load_dwordx4 a[24:27], v2, s[32:35], s59 offen offset:2048 nt
    s_waitcnt vmcnt(5)
    buffer_load_dwordx4 a[28:31], v2, s[32:35], s59 offen offset:3072 nt
    s_mov_b32 s59, 32768
    s_waitcnt vmcnt(5)
    buffer_load_dwordx4 a[32:35], v2, s[32:35], s59 offen offset:0 nt
    s_waitcnt vmcnt(5)
    buffer_load_dwordx4 a[36:39], v2, s[32:35], s59 offen offset:1024 nt
    s_waitcnt vmcnt(5)
    buffer_load_dwordx4 a[40:43], v2, s[32:35], s59 offen offset:2048 nt
    s_waitcnt vmcnt(4)
    buffer_load_dwordx4 a[44:47], v2, s[32:35], s59 offen offset:3072 nt
    s_mov_b32 s59, 49152
    s_waitcnt vmcnt(4)
    buffer_load_dwordx4 a[48:51], v2, s[32:35], s59 offen offset:0 nt
    s_waitcnt vmcnt(4)
    buffer_load_dwordx4 a[52:55], v2, s[32:35], s59 offen offset:1024 nt
    s_waitcnt vmcnt(4)
    buffer_load_dwordx4 a[56:59], v2, s[32:35], s59 offen offset:2048 nt
    s_waitcnt vmcnt(4)
    buffer_load_dwordx4 a[60:63], v2, s[32:35], s59 offen offset:3072 nt
    s_mov_b32 s59, 65536
    s_waitcnt vmcnt(4)
    buffer_load_dwordx4 a[64:67], v2, s[32:35], s59 offen offset:0 nt
    s_waitcnt vmcnt(4)
    buffer_load_dwordx4 a[68:71], v2, s[32:35], s59 offen offset:1024 nt
    s_waitcnt vmcnt(4)
    buffer_load_dwordx4 a[72:75], v2, s[32:35], s59 offen offset:2048 nt
    s_waitcnt vmcnt(4)
    buffer_load_dwordx4 a[76:79], v2, s[32:35], s59 offen offset:3072 nt
    s_mov_b32 s59, 81920
    s_waitcnt vmcnt(4)
    buffer_load_dwordx4 a[80:83], v2, s[32:35], s59 offen offset:0 nt
    s_waitcnt vmcnt(4)
    buffer_load_dwordx4 a[84:87], v2, s[32:35], s59 offen offset:1024 nt
    s_waitcnt vmcnt(4)
    buffer_load_dwordx4 a[88:91], v2, s[32:35], s59 offen offset:2048 nt
    s_waitcnt vmcnt(4)
    buffer_load_dwordx4 a[92:95], v2, s[32:35], s59 offen offset:3072 nt
    s_waitcnt lgkmcnt(0)
    s_add_u32 s58, s58, 1
    s_mov_b32 s59, 98304
    s_waitcnt vmcnt(4)
    buffer_load_dwordx4 a[96:99], v2, s[32:35], s59 offen offset:0 nt
    s_waitcnt vmcnt(4)
    buffer_load_dwordx4 a[100:103], v2, s[32:35], s59 offen offset:1024 nt
    s_waitcnt vmcnt(4)
    buffer_load_dwordx4 a[104:107], v2, s[32:35], s59 offen offset:2048 nt
    s_waitcnt vmcnt(4)
    buffer_load_dwordx4 a[108:111], v2, s[32:35], s59 offen offset:3072 nt
    s_mov_b32 s59, 114688
    s_waitcnt vmcnt(4)
    buffer_load_dwordx4 a[112:115], v2, s[32:35], s59 offen offset:0 nt
    s_waitcnt vmcnt(4)
    buffer_load_dwordx4 a[116:119], v2, s[32:35], s59 offen offset:1024 nt
    s_waitcnt vmcnt(4)
    buffer_load_dwordx4 a[120:123], v2, s[32:35], s59 offen offset:2048 nt
    s_waitcnt vmcnt(4)
    buffer_load_dwordx4 a[124:127], v2, s[32:35], s59 offen offset:3072 nt
    s_mov_b32 s59, 131072
    s_waitcnt vmcnt(4)
    buffer_load_dwordx4 a[128:131], v2, s[32:35], s59 offen offset:0 nt
    s_waitcnt vmcnt(4)
    buffer_load_dwordx4 a[132:135], v2, s[32:35], s59 offen offset:1024 nt
    s_waitcnt vmcnt(4)
    buffer_load_dwordx4 a[136:139], v2, s[32:35], s59 offen offset:2048 nt
    s_waitcnt vmcnt(4)
    buffer_load_dwordx4 a[140:143], v2, s[32:35], s59 offen offset:3072 nt
    s_mov_b32 s59, 147456
    s_waitcnt vmcnt(4)
    buffer_load_dwordx4 a[144:147], v2, s[32:35], s59 offen offset:0 nt
    s_waitcnt vmcnt(4)
    buffer_load_dwordx4 a[148:151], v2, s[32:35], s59 offen offset:1024 nt
    s_waitcnt vmcnt(4)
    buffer_load_dwordx4 a[152:155], v2, s[32:35], s59 offen offset:2048 nt
    s_waitcnt vmcnt(4)
    buffer_load_dwordx4 a[156:159], v2, s[32:35], s59 offen offset:3072 nt
    s_mov_b32 s59, 163840
    s_waitcnt vmcnt(4)
    buffer_load_dwordx4 a[160:163], v2, s[32:35], s59 offen offset:0 nt
    s_waitcnt vmcnt(4)
    buffer_load_dwordx4 a[164:167], v2, s[32:35], s59 offen offset:1024 nt
    s_waitcnt vmcnt(4)
    buffer_load_dwordx4 a[168:171], v2, s[32:35], s59 offen offset:2048 nt
    s_waitcnt vmcnt(4)
    buffer_load_dwordx4 a[172:175], v2, s[32:35], s59 offen offset:3072 nt
    s_lshl_b32 s61, s54, 14
    s_lshl_b32 s62, s53, 11
    s_add_u32 s61, s61, s62
    s_add_u32 s61, s61, 65536
    v_bfe_u32 v15, v1, 2, 2
    v_lshlrev_b32 v15, 9, v15
    v_lshrrev_b32 v6, 4, v1
    v_lshl_add_u32 v15, v6, 7, v15
    v_and_b32 v7, 3, v1
    v_lshl_add_u32 v15, v7, 5, v15
    v_add_u32 v15, s61, v15
    s_mov_b32 s59, 180224
    s_waitcnt vmcnt(4)
    buffer_load_dwordx4 a[176:179], v2, s[32:35], s59 offen offset:0 nt
    s_waitcnt vmcnt(4)
    buffer_load_dwordx4 a[180:183], v2, s[32:35], s59 offen offset:1024 nt
    s_waitcnt vmcnt(4)
    buffer_load_dwordx4 a[184:187], v2, s[32:35], s59 offen offset:2048 nt
    s_waitcnt vmcnt(4)
    buffer_load_dwordx4 a[188:191], v2, s[32:35], s59 offen offset:3072 nt
    s_mov_b32 s59, 196608
    s_waitcnt vmcnt(4)
    buffer_load_dwordx4 a[192:195], v2, s[32:35], s59 offen offset:0 nt
    s_waitcnt vmcnt(4)
    buffer_load_dwordx4 a[196:199], v2, s[32:35], s59 offen offset:1024 nt
    s_waitcnt vmcnt(4)
    buffer_load_dwordx4 a[200:203], v2, s[32:35], s59 offen offset:2048 nt
    s_waitcnt vmcnt(4)
    buffer_load_dwordx4 a[204:207], v2, s[32:35], s59 offen offset:3072 nt
    s_mov_b32 s59, 212992
    s_waitcnt vmcnt(4)
    buffer_load_dwordx4 a[208:211], v2, s[32:35], s59 offen offset:0 nt
    s_waitcnt vmcnt(4)
    buffer_load_dwordx4 a[212:215], v2, s[32:35], s59 offen offset:1024 nt
    s_waitcnt vmcnt(4)
    buffer_load_dwordx4 a[216:219], v2, s[32:35], s59 offen offset:2048 nt
    s_waitcnt vmcnt(4)
    buffer_load_dwordx4 a[220:223], v2, s[32:35], s59 offen offset:3072 nt
    s_mov_b32 s59, 229376
    s_waitcnt vmcnt(4)
    buffer_load_dwordx4 a[224:227], v2, s[32:35], s59 offen offset:0 nt
    s_waitcnt vmcnt(4)
    buffer_load_dwordx4 a[228:231], v2, s[32:35], s59 offen offset:1024 nt
    s_waitcnt vmcnt(4)
    buffer_load_dwordx4 a[232:235], v2, s[32:35], s59 offen offset:2048 nt
    s_waitcnt vmcnt(4)
    buffer_load_dwordx4 a[236:239], v2, s[32:35], s59 offen offset:3072 nt
    s_mov_b32 s59, 245760
    s_waitcnt vmcnt(4)
    buffer_load_dwordx4 a[240:243], v2, s[32:35], s59 offen offset:0 nt
    s_waitcnt vmcnt(4)
    buffer_load_dwordx4 a[244:247], v2, s[32:35], s59 offen offset:1024 nt
    s_waitcnt vmcnt(4)
    buffer_load_dwordx4 a[248:251], v2, s[32:35], s59 offen offset:2048 nt
    s_waitcnt vmcnt(4)
    buffer_load_dwordx4 a[252:255], v2, s[32:35], s59 offen offset:3072 nt
    buffer_load_dwordx4 v[80:83], v15, s[48:51], 0 offen sc1
    buffer_load_dwordx4 v[84:87], v15, s[48:51], 0 offen offset:16 sc1
    s_mov_b32 s59, 0
    s_waitcnt vmcnt(6)
    buffer_load_dwordx4 v[96:99], v3, s[36:39], s59 offen offset:0 nt
    s_waitcnt vmcnt(6)
    buffer_load_dwordx4 v[100:103], v3, s[36:39], s59 offen offset:1024 nt
    s_waitcnt vmcnt(6)
    buffer_load_dwordx4 v[104:107], v3, s[36:39], s59 offen offset:2048 nt
    s_waitcnt vmcnt(6)
    buffer_load_dwordx4 v[108:111], v3, s[36:39], s59 offen offset:3072 nt
    s_mov_b32 s59, 16384
    s_waitcnt vmcnt(6)
    buffer_load_dwordx4 v[112:115], v3, s[36:39], s59 offen offset:0 nt
    s_waitcnt vmcnt(4)
    buffer_load_dwordx4 v[116:119], v3, s[36:39], s59 offen offset:1024 nt
    s_waitcnt vmcnt(4)
    buffer_load_dwordx4 v[120:123], v3, s[36:39], s59 offen offset:2048 nt
    s_waitcnt vmcnt(4)
    buffer_load_dwordx4 v[124:127], v3, s[36:39], s59 offen offset:3072 nt
    s_mov_b32 s59, 32768
    s_waitcnt vmcnt(5)
    buffer_load_dwordx4 v[128:131], v3, s[36:39], s59 offen offset:0 nt
    s_waitcnt vmcnt(5)
    buffer_load_dwordx4 v[132:135], v3, s[36:39], s59 offen offset:1024 nt
    s_waitcnt vmcnt(5)
    buffer_load_dwordx4 v[136:139], v3, s[36:39], s59 offen offset:2048 nt
    s_waitcnt vmcnt(5)
    buffer_load_dwordx4 v[140:143], v3, s[36:39], s59 offen offset:3072 nt
    s_mov_b32 s59, 49152
    s_waitcnt vmcnt(5)
    buffer_load_dwordx4 v[144:147], v3, s[36:39], s59 offen offset:0 nt
    s_waitcnt vmcnt(5)
    buffer_load_dwordx4 v[148:151], v3, s[36:39], s59 offen offset:1024 nt
    s_waitcnt vmcnt(5)
    buffer_load_dwordx4 v[152:155], v3, s[36:39], s59 offen offset:2048 nt
    s_waitcnt vmcnt(5)
    buffer_load_dwordx4 v[156:159], v3, s[36:39], s59 offen offset:3072 nt
L_join:
    s_waitcnt vmcnt(16)
L_q_chk:
    v_xor_b32 v14, s58, v81
    v_bitop3_b32 v14, v14, v83, s58 bitop3:0xf6
    v_bitop3_b32 v14, v14, v85, s58 bitop3:0xf6
    v_bitop3_b32 v14, v14, v87, s58 bitop3:0xf6
    v_cmp_ne_u32 vcc, 0, v14
    s_nop 0
    s_cbranch_vccz L_q_ok
    s_cmp_eq_u32 s73, 0
    s_cbranch_scc1 L_q_ok
    s_sub_u32 s73, s73, 1
    s_and_b32 s61, s73, 255
    s_cbranch_scc1 L_q_nf
    s_waitcnt vmcnt(0)
    buffer_wbl2 sc1
L_q_nf:
    s_mov_b64 exec, vcc
    buffer_load_dwordx4 v[80:83], v15, s[48:51], 0 offen sc1
    buffer_load_dwordx4 v[84:87], v15, s[48:51], 0 offen offset:16 sc1
    s_mov_b64 exec, -1
    s_waitcnt vmcnt(0)
    s_branch L_q_chk
L_q_ok:
    v_mov_b32 v40, v80
    v_mov_b32 v41, v82
    v_mov_b32 v42, v84
    v_mov_b32 v43, v86
    s_nop 1
    v_mfma_f32_16x16x32_bf16 v[48:51], a[0:3], v[40:43], 0
    v_mfma_f32_16x16x32_bf16 v[52:55], a[4:7], v[40:43], 0
    v_mfma_f32_16x16x32_bf16 v[56:59], a[8:11], v[40:43], 0
    v_mfma_f32_16x16x32_bf16 v[60:63], a[12:15], v[40:43], 0
    v_mfma_f32_16x16x32_bf16 v[64:67], a[16:19], v[40:43], 0
    v_mfma_f32_16x16x32_bf16 v[68:71], a[20:23], v[40:43], 0
    v_mfma_f32_16x16x32_bf16 v[72:75], a[24:27], v[40:43], 0
    v_mfma_f32_16x16x32_bf16 v[76:79], a[28:31], v[40:43], 0
    s_nop 0
    v_add_f32_dpp v48, v49, v48 quad_perm:[1,1,1,1] row_mask:0xf bank_mask:0xf
    v_add_f32_dpp v53, v54, v53 quad_perm:[2,2,2,2] row_mask:0xf bank_mask:0xf
    v_add_f32_dpp v58, v59, v58 quad_perm:[3,3,3,3] row_mask:0xf bank_mask:0xf
    v_add_f32_dpp v63, v60, v63 quad_perm:[0,0,0,0] row_mask:0xf bank_mask:0xf
    v_add_f32_dpp v48, v50, v48 quad_perm:[2,2,2,2] row_mask:0xf bank_mask:0xf
    v_add_f32_dpp v53, v55, v53 quad_perm:[3,3,3,3] row_mask:0xf bank_mask:0xf
    v_add_f32_dpp v58, v56, v58 quad_perm:[0,0,0,0] row_mask:0xf bank_mask:0xf
    v_add_f32_dpp v63, v61, v63 quad_perm:[1,1,1,1] row_mask:0xf bank_mask:0xf
    v_add_f32_dpp v16, v51, v48 quad_perm:[3,3,3,3] row_mask:0xf bank_mask:0xf
    v_add_f32_dpp v53, v52, v53 quad_perm:[0,0,0,0] row_mask:0xf bank_mask:0xf
    v_add_f32_dpp v58, v57, v58 quad_perm:[1,1,1,1] row_mask:0xf bank_mask:0xf
    v_add_f32_dpp v63, v62, v63 quad_perm:[2,2,2,2] row_mask:0xf bank_mask:0xf
    v_cndmask_b32 v16, v16, v53, s[64:65]
    v_cndmask_b32 v16, v16, v58, s[66:67]
    v_cndmask_b32 v16, v16, v63, s[68:69]
    v_mfma_f32_16x16x32_bf16 v[48:51], a[32:35], v[40:43], 0
    v_mfma_f32_16x16x32_bf16 v[52:55], a[36:39], v[40:43], 0
    v_mfma_f32_16x16x32_bf16 v[56:59], a[40:43], v[40:43], 0
    v_mfma_f32_16x16x32_bf16 v[60:63], a[44:47], v[40:43], 0
    v_add_f32_dpp v64, v65, v64 quad_perm:[1,1,1,1] row_mask:0xf bank_mask:0xf
    v_add_f32_dpp v69, v70, v69 quad_perm:[2,2,2,2] row_mask:0xf bank_mask:0xf
    v_add_f32_dpp v74, v75, v74 quad_perm:[3,3,3,3] row_mask:0xf bank_mask:0xf
    v_add_f32_dpp v79, v76, v79 quad_perm:[0,0,0,0] row_mask:0xf bank_mask:0xf
    v_add_f32_dpp v64, v66, v64 quad_perm:[2,2,2,2] row_mask:0xf bank_mask:0xf
    v_add_f32_dpp v69, v71, v69 quad_perm:[3,3,3,3] row_mask:0xf bank_mask:0xf
    v_add_f32_dpp v74, v72, v74 quad_perm:[0,0,0,0] row_mask:0xf bank_mask:0xf
    v_add_f32_dpp v79, v77, v79 quad_perm:[1,1,1,1] row_mask:0xf bank_mask:0xf
    v_add_f32_dpp v17, v67, v64 quad_perm:[3,3,3,3] row_mask:0xf bank_mask:0xf
    v_add_f32_dpp v69, v68, v69 quad_perm:[0,0,0,0] row_mask:0xf bank_mask:0xf
    v_add_f32_dpp v74, v73, v74 quad_perm:[1,1,1,1] row_mask:0xf bank_mask:0xf
    v_add_f32_dpp v79, v78, v79 quad_perm:[2,2,2,2] row_mask:0xf bank_mask:0xf
    v_cndmask_b32 v17, v17, v69, s[64:65]
    v_cndmask_b32 v17, v17, v74, s[66:67]
    v_cndmask_b32 v17, v17, v79, s[68:69]
    s_mov_b32 s59, 65536
    s_waitcnt vmcnt(5)
    buffer_load_dwordx4 v[160:163], v3, s[36:39], s59 offen offset:0 nt
    v_mfma_f32_16x16x32_bf16 v[64:67], a[48:51], v[40:43], 0
    v_mfma_f32_16x16x32_bf16 v[68:71], a[52:55], v[40:43], 0
    v_mfma_f32_16x16x32_bf16 v[72:75], a[56:59], v[40:43], 0
    v_mfma_f32_16x16x32_bf16 v[76:79], a[60:63], v[40:43], 0
    v_add_f32_dpp v48, v49, v48 quad_perm:[1,1,1,1] row_mask:0xf bank_mask:0xf
    v_add_f32_dpp v53, v54, v53 quad_perm:[2,2,2,2] row_mask:0xf bank_mask:0xf
    v_add_f32_dpp v58, v59, v58 quad_perm:[3,3,3,3] row_mask:0xf bank_mask:0xf
    v_add_f32_dpp v63, v60, v63 quad_perm:[0,0,0,0] row_mask:0xf bank_mask:0xf
    v_add_f32_dpp v48, v50, v48 quad_perm:[2,2,2,2] row_mask:0xf bank_mask:0xf
    v_add_f32_dpp v53, v55, v53 quad_perm:[3,3,3,3] row_mask:0xf bank_mask:0xf
    v_add_f32_dpp v58, v56, v58 quad_perm:[0,0,0,0] row_mask:0xf bank_mask:0xf
    v_add_f32_dpp v63, v61, v63 quad_perm:[1,1,1,1] row_mask:0xf bank_mask:0xf
    v_add_f32_dpp v18, v51, v48 quad_perm:[3,3,3,3] row_mask:0xf bank_mask:0xf
    v_add_f32_dpp v53, v52, v53 quad_perm:[0,0,0,0] row_mask:0xf bank_mask:0xf
    v_add_f32_dpp v58, v57, v58 quad_perm:[1,1,1,1] row_mask:0xf bank_mask:0xf
    v_add_f32_dpp v63, v62, v63 quad_perm:[2,2,2,2] row_mask:0xf bank_mask:0xf
    v_cndmask_b32 v18, v18, v53, s[64:65]
    v_cndmask_b32 v18, v18, v58, s[66:67]
    v_cndmask_b32 v18, v18, v63, s[68:69]
    v_mfma_f32_16x16x32_bf16 v[48:51], a[64:67], v[40:43], 0
    v_mfma_f32_16x16x32_bf16 v[52:55], a[68:71], v[40:43], 0
    v_mfma_f32_16x16x32_bf16 v[56:59], a[72:75], v[40:43], 0
    v_mfma_f32_16x16x32_bf16 v[60:63], a[76:79], v[40:43], 0
    v_add_f32_dpp v64, v65, v64 quad_perm:[1,1,1,1] row_mask:0xf bank_mask:0xf
    v_add_f32_dpp v69, v70, v69 quad_perm:[2,2,2,2] row_mask:0xf bank_mask:0xf
    v_add_f32_dpp v74, v75, v74 quad_perm:[3,3,3,3] row_mask:0xf bank_mask:0xf
    v_add_f32_dpp v79, v76, v79 quad_perm:[0,0,0,0] row_mask:0xf bank_mask:0xf
    v_add_f32_dpp v64, v66, v64 quad_perm:[2,2,2,2] row_mask:0xf bank_mask:0xf
    v_add_f32_dpp v69, v71, v69 quad_perm:[3,3,3,3] row_mask:0xf bank_mask:0xf
    v_add_f32_dpp v74, v72, v74 quad_perm:[0,0,0,0] row_mask:0xf bank_mask:0xf
    v_add_f32_dpp v79, v77, v79 quad_perm:[1,1,1,1] row_mask:0xf bank_mask:0xf
    v_add_f32_dpp v19, v67, v64 quad_perm:[3,3,3,3] row_mask:0xf bank_mask:0xf
    v_add_f32_dpp v69, v68, v69 quad_perm:[0,0,0,0] row_mask:0xf bank_mask:0xf
    v_add_f32_dpp v74, v73, v74 quad_perm:[1,1,1,1] row_mask:0xf bank_mask:0xf
    v_add_f32_dpp v79, v78, v79 quad_perm:[2,2,2,2] row_mask:0xf bank_mask:0xf
    v_cndmask_b32 v19, v19, v69, s[64:65]
    v_cndmask_b32 v19, v19, v74, s[66:67]
    v_cndmask_b32 v19, v19, v79, s[68:69]
    s_waitcnt vmcnt(5)
    buffer_load_dwordx4 v[164:167], v3, s[36:39], s59 offen offset:1024 nt
    v_mfma_f32_16x16x32_bf16 v[64:67], a[80:83], v[40:43], 0
    v_mfma_f32_16x16x32_bf16 v[68:71], a[84:87], v[40:43], 0
    v_mfma_f32_16x16x32_bf16 v[72:75], a[88:91], v[40:43], 0
    v_mfma_f32_16x16x32_bf16 v[76:79], a[92:95], v[40:43], 0
    v_add_f32_dpp v48, v49, v48 quad_perm:[1,1,1,1] row_mask:0xf bank_mask:0xf
    v_add_f32_dpp v53, v54, v53 quad_perm:[2,2,2,2] row_mask:0xf bank_mask:0xf
    v_add_f32_dpp v58, v59, v58 quad_perm:[3,3,3,3] row_mask:0xf bank_mask:0xf
    v_add_f32_dpp v63, v60, v63 quad_perm:[0,0,0,0] row_mask:0xf bank_mask:0xf
    v_add_f32_dpp v48, v50, v48 quad_perm:[2,2,2,2] row_mask:0xf bank_mask:0xf
    v_add_f32_dpp v53, v55, v53 quad_perm:[3,3,3,3] row_mask:0xf bank_mask:0xf
    v_add_f32_dpp v58, v56, v58 quad_perm:[0,0,0,0] row_mask:0xf bank_mask:0xf
    v_add_f32_dpp v63, v61, v63 quad_perm:[1,1,1,1] row_mask:0xf bank_mask:0xf
    v_add_f32_dpp v20, v51, v48 quad_perm:[3,3,3,3] row_mask:0xf bank_mask:0xf
    v_add_f32_dpp v53, v52, v53 quad_perm:[0,0,0,0] row_mask:0xf bank_mask:0xf
    v_add_f32_dpp v58, v57, v58 quad_perm:[1,1,1,1] row_mask:0xf bank_mask:0xf
    v_add_f32_dpp v63, v62, v63 quad_perm:[2,2,2,2] row_mask:0xf bank_mask:0xf
    v_cndmask_b32 v20, v20, v53, s[64:65]
    v_cndmask_b32 v20, v20, v58, s[66:67]
    v_cndmask_b32 v20, v20, v63, s[68:69]
    v_mfma_f32_16x16x32_bf16 v[48:51], a[96:99], v[40:43], 0
    v_mfma_f32_16x16x32_bf16 v[52:55], a[100:103], v[40:43], 0
    v_mfma_f32_16x16x32_bf16 v[56:59], a[104:107], v[40:43], 0
    v_mfma_f32_16x16x32_bf16 v[60:63], a[108:111], v[40:43], 0
    v_add_f32_dpp v64, v65, v64 quad_perm:[1,1,1,1] row_mask:0xf bank_mask:0xf
    v_add_f32_dpp v69, v70, v69 quad_perm:[2,2,2,2] row_mask:0xf bank_mask:0xf
    v_add_f32_dpp v74, v75, v74 quad_perm:[3,3,3,3] row_mask:0xf bank_mask:0xf
    v_add_f32_dpp v79, v76, v79 quad_perm:[0,0,0,0] row_mask:0xf bank_mask:0xf
    v_add_f32_dpp v64, v66, v64 quad_perm:[2,2,2,2] row_mask:0xf bank_mask:0xf
    v_add_f32_dpp v69, v71, v69 quad_perm:[3,3,3,3] row_mask:0xf bank_mask:0xf
    v_add_f32_dpp v74, v72, v74 quad_perm:[0,0,0,0] row_mask:0xf bank_mask:0xf
    v_add_f32_dpp v79, v77, v79 quad_perm:[1,1,1,1] row_mask:0xf bank_mask:0xf
    v_add_f32_dpp v21, v67, v64 quad_perm:[3,3,3,3] row_mask:0xf bank_mask:0xf
    v_add_f32_dpp v69, v68, v69 quad_perm:[0,0,0,0] row_mask:0xf bank_mask:0xf
    v_add_f32_dpp v74, v73, v74 quad_perm:[1,1,1,1] row_mask:0xf bank_mask:0xf
    v_add_f32_dpp v79, v78, v79 quad_perm:[2,2,2,2] row_mask:0xf bank_mask:0xf
    v_cndmask_b32 v21, v21, v69, s[64:65]
    v_cndmask_b32 v21, v21, v74, s[66:67]
    v_cndmask_b32 v21, v21, v79, s[68:69]
    s_waitcnt vmcnt(5)
    buffer_load_dwordx4 v[168:171], v3, s[36:39], s59 offen offset:2048 nt
    v_mfma_f32_16x16x32_bf16 v[64:67], a[112:115], v[40:43], 0
    v_mfma_f32_16x16x32_bf16 v[68:71], a[116:119], v[40:43], 0
    v_mfma_f32_16x16x32_bf16 v[72:75], a[120:123], v[40:43], 0
    v_mfma_f32_16x16x32_bf16 v[76:79], a[124:127], v[40:43], 0
    v_add_f32_dpp v48, v49, v48 quad_perm:[1,1,1,1] row_mask:0xf bank_mask:0xf
    v_add_f32_dpp v53, v54, v53 quad_perm:[2,2,2,2] row_mask:0xf bank_mask:0xf
    v_add_f32_dpp v58, v59, v58 quad_perm:[3,3,3,3] row_mask:0xf bank_mask:0xf
    v_add_f32_dpp v63, v60, v63 quad_perm:[0,0,0,0] row_mask:0xf bank_mask:0xf
    v_add_f32_dpp v48, v50, v48 quad_perm:[2,2,2,2] row_mask:0xf bank_mask:0xf
    v_add_f32_dpp v53, v55, v53 quad_perm:[3,3,3,3] row_mask:0xf bank_mask:0xf
    v_add_f32_dpp v58, v56, v58 quad_perm:[0,0,0,0] row_mask:0xf bank_mask:0xf
    v_add_f32_dpp v63, v61, v63 quad_perm:[1,1,1,1] row_mask:0xf bank_mask:0xf
    v_add_f32_dpp v22, v51, v48 quad_perm:[3,3,3,3] row_mask:0xf bank_mask:0xf
    v_add_f32_dpp v53, v52, v53 quad_perm:[0,0,0,0] row_mask:0xf bank_mask:0xf
    v_add_f32_dpp v58, v57, v58 quad_perm:[1,1,1,1] row_mask:0xf bank_mask:0xf
    v_add_f32_dpp v63, v62, v63 quad_perm:[2,2,2,2] row_mask:0xf bank_mask:0xf
    v_cndmask_b32 v22, v22, v53, s[64:65]
    v_cndmask_b32 v22, v22, v58, s[66:67]
    v_cndmask_b32 v22, v22, v63, s[68:69]
    v_mfma_f32_16x16x32_bf16 v[48:51], a[128:131], v[40:43], 0
    v_mfma_f32_16x16x32_bf16 v[52:55], a[132:135], v[40:43], 0
    v_mfma_f32_16x16x32_bf16 v[56:59], a[136:139], v[40:43], 0
    v_mfma_f32_16x16x32_bf16 v[60:63], a[140:143], v[40:43], 0
    v_add_f32_dpp v64, v65, v64 quad_perm:[1,1,1,1] row_mask:0xf bank_mask:0xf
    v_add_f32_dpp v69, v70, v69 quad_perm:[2,2,2,2] row_mask:0xf bank_mask:0xf
    v_add_f32_dpp v74, v75, v74 quad_perm:[3,3,3,3] row_mask:0xf bank_mask:0xf
    v_add_f32_dpp v79, v76, v79 quad_perm:[0,0,0,0] row_mask:0xf bank_mask:0xf
    v_add_f32_dpp v64, v66, v64 quad_perm:[2,2,2,2] row_mask:0xf bank_mask:0xf
    v_add_f32_dpp v69, v71, v69 quad_perm:[3,3,3,3] row_mask:0xf bank_mask:0xf
    v_add_f32_dpp v74, v72, v74 quad_perm:[0,0,0,0] row_mask:0xf bank_mask:0xf
    v_add_f32_dpp v79, v77, v79 quad_perm:[1,1,1,1] row_mask:0xf bank_mask:0xf
    v_add_f32_dpp v23, v67, v64 quad_perm:[3,3,3,3] row_mask:0xf bank_mask:0xf
    v_add_f32_dpp v69, v68, v69 quad_perm:[0,0,0,0] row_mask:0xf bank_mask:0xf
    v_add_f32_dpp v74, v73, v74 quad_perm:[1,1,1,1] row_mask:0xf bank_mask:0xf
    v_add_f32_dpp v79, v78, v79 quad_perm:[2,2,2,2] row_mask:0xf bank_mask:0xf
    v_cndmask_b32 v23, v23, v69, s[64:65]
    v_cndmask_b32 v23, v23, v74, s[66:67]
    v_cndmask_b32 v23, v23, v79, s[68:69]
    s_waitcnt vmcnt(5)
    buffer_load_dwordx4 v[172:175], v3, s[36:39], s59 offen offset:3072 nt
    v_mfma_f32_16x16x32_bf16 v[64:67], a[144:147], v[40:43], 0
    v_mfma_f32_16x16x32_bf16 v[68:71], a[148:151], v[40:43], 0
    v_mfma_f32_16x16x32_bf16 v[72:75], a[152:155], v[40:43], 0
    v_mfma_f32_16x16x32_bf16 v[76:79], a[156:159], v[40:43], 0
    v_add_f32_dpp v48, v49, v48 quad_perm:[1,1,1,1] row_mask:0xf bank_mask:0xf
    v_add_f32_dpp v53, v54, v53 quad_perm:[2,2,2,2] row_mask:0xf bank_mask:0xf
    v_add_f32_dpp v58, v59, v58 quad_perm:[3,3,3,3] row_mask:0xf bank_mask:0xf
    v_add_f32_dpp v63, v60, v63 quad_perm:[0,0,0,0] row_mask:0xf bank_mask:0xf
    v_add_f32_dpp v48, v50, v48 quad_perm:[2,2,2,2] row_mask:0xf bank_mask:0xf
    v_add_f32_dpp v53, v55, v53 quad_perm:[3,3,3,3] row_mask:0xf bank_mask:0xf
    v_add_f32_dpp v58, v56, v58 quad_perm:[0,0,0,0] row_mask:0xf bank_mask:0xf
    v_add_f32_dpp v63, v61, v63 quad_perm:[1,1,1,1] row_mask:0xf bank_mask:0xf
    v_add_f32_dpp v24, v51, v48 quad_perm:[3,3,3,3] row_mask:0xf bank_mask:0xf
    v_add_f32_dpp v53, v52, v53 quad_perm:[0,0,0,0] row_mask:0xf bank_mask:0xf
    v_add_f32_dpp v58, v57, v58 quad_perm:[1,1,1,1] row_mask:0xf bank_mask:0xf
    v_add_f32_dpp v63, v62, v63 quad_perm:[2,2,2,2] row_mask:0xf bank_mask:0xf
    v_cndmask_b32 v24, v24, v53, s[64:65]
    v_cndmask_b32 v24, v24, v58, s[66:67]
    v_cndmask_b32 v24, v24, v63, s[68:69]
    v_mfma_f32_16x16x32_bf16 v[48:51], a[160:163], v[40:43], 0
    v_mfma_f32_16x16x32_bf16 v[52:55], a[164:167], v[40:43], 0
    v_mfma_f32_16x16x32_bf16 v[56:59], a[168:171], v[40:43], 0
    v_mfma_f32_16x16x32_bf16 v[60:63], a[172:175], v[40:43], 0
    v_add_f32_dpp v64, v65, v64 quad_perm:[1,1,1,1] row_mask:0xf bank_mask:0xf
    v_add_f32_dpp v69, v70, v69 quad_perm:[2,2,2,2] row_mask:0xf bank_mask:0xf
    v_add_f32_dpp v74, v75, v74 quad_perm:[3,3,3,3] row_mask:0xf bank_mask:0xf
    v_add_f32_dpp v79, v76, v79 quad_perm:[0,0,0,0] row_mask:0xf bank_mask:0xf
    v_add_f32_dpp v64, v66, v64 quad_perm:[2,2,2,2] row_mask:0xf bank_mask:0xf
    v_add_f32_dpp v69, v71, v69 quad_perm:[3,3,3,3] row_mask:0xf bank_mask:0xf
    v_add_f32_dpp v74, v72, v74 quad_perm:[0,0,0,0] row_mask:0xf bank_mask:0xf
    v_add_f32_dpp v79, v77, v79 quad_perm:[1,1,1,1] row_mask:0xf bank_mask:0xf
    v_add_f32_dpp v25, v67, v64 quad_perm:[3,3,3,3] row_mask:0xf bank_mask:0xf
    v_add_f32_dpp v69, v68, v69 quad_perm:[0,0,0,0] row_mask:0xf bank_mask:0xf
    v_add_f32_dpp v74, v73, v74 quad_perm:[1,1,1,1] row_mask:0xf bank_mask:0xf
    v_add_f32_dpp v79, v78, v79 quad_perm:[2,2,2,2] row_mask:0xf bank_mask:0xf
    v_cndmask_b32 v25, v25, v69, s[64:65]
    v_cndmask_b32 v25, v25, v74, s[66:67]
    v_cndmask_b32 v25, v25, v79, s[68:69]
    s_mov_b32 s59, 81920
    s_waitcnt vmcnt(5)
    buffer_load_dwordx4 v[176:179], v3, s[36:39], s59 offen offset:0 nt
    v_mfma_f32_16x16x32_bf16 v[64:67], a[176:179], v[40:43], 0
    v_mfma_f32_16x16x32_bf16 v[68:71], a[180:183], v[40:43], 0
    v_mfma_f32_16x16x32_bf16 v[72:75], a[184:187], v[40:43], 0
    v_mfma_f32_16x16x32_bf16 v[76:79], a[188:191], v[40:43], 0
    v_add_f32_dpp v48, v49, v48 quad_perm:[1,1,1,1] row_mask:0xf bank_mask:0xf
    v_add_f32_dpp v53, v54, v53 quad_perm:[2,2,2,2] row_mask:0xf bank_mask:0xf
    v_add_f32_dpp v58, v59, v58 quad_perm:[3,3,3,3] row_mask:0xf bank_mask:0xf
    v_add_f32_dpp v63, v60, v63 quad_perm:[0,0,0,0] row_mask:0xf bank_mask:0xf
    v_add_f32_dpp v48, v50, v48 quad_perm:[2,2,2,2] row_mask:0xf bank_mask:0xf
    v_add_f32_dpp v53, v55, v53 quad_perm:[3,3,3,3] row_mask:0xf bank_mask:0xf
    v_add_f32_dpp v58, v56, v58 quad_perm:[0,0,0,0] row_mask:0xf bank_mask:0xf
    v_add_f32_dpp v63, v61, v63 quad_perm:[1,1,1,1] row_mask:0xf bank_mask:0xf
    v_add_f32_dpp v26, v51, v48 quad_perm:[3,3,3,3] row_mask:0xf bank_mask:0xf
    v_add_f32_dpp v53, v52, v53 quad_perm:[0,0,0,0] row_mask:0xf bank_mask:0xf
    v_add_f32_dpp v58, v57, v58 quad_perm:[1,1,1,1] row_mask:0xf bank_mask:0xf
    v_add_f32_dpp v63, v62, v63 quad_perm:[2,2,2,2] row_mask:0xf bank_mask:0xf
    v_cndmask_b32 v26, v26, v53, s[64:65]
    v_cndmask_b32 v26, v26, v58, s[66:67]
    v_cndmask_b32 v26, v26, v63, s[68:69]
    v_mfma_f32_16x16x32_bf16 v[48:51], a[192:195], v[40:43], 0
    v_mfma_f32_16x16x32_bf16 v[52:55], a[196:199], v[40:43], 0
    v_mfma_f32_16x16x32_bf16 v[56:59], a[200:203], v[40:43], 0
    v_mfma_f32_16x16x32_bf16 v[60:63], a[204:207], v[40:43], 0
    v_add_f32_dpp v64, v65, v64 quad_perm:[1,1,1,1] row_mask:0xf bank_mask:0xf
    v_add_f32_dpp v69, v70, v69 quad_perm:[2,2,2,2] row_mask:0xf bank_mask:0xf
    v_add_f32_dpp v74, v75, v74 quad_perm:[3,3,3,3] row_mask:0xf bank_mask:0xf
    v_add_f32_dpp v79, v76, v79 quad_perm:[0,0,0,0] row_mask:0xf bank_mask:0xf
    v_add_f32_dpp v64, v66, v64 quad_perm:[2,2,2,2] row_mask:0xf bank_mask:0xf
    v_add_f32_dpp v69, v71, v69 quad_perm:[3,3,3,3] row_mask:0xf bank_mask:0xf
    v_add_f32_dpp v74, v72, v74 quad_perm:[0,0,0,0] row_mask:0xf bank_mask:0xf
    v_add_f32_dpp v79, v77, v79 quad_perm:[1,1,1,1] row_mask:0xf bank_mask:0xf
    v_add_f32_dpp v27, v67, v64 quad_perm:[3,3,3,3] row_mask:0xf bank_mask:0xf
    v_add_f32_dpp v69, v68, v69 quad_perm:[0,0,0,0] row_mask:0xf bank_mask:0xf
    v_add_f32_dpp v74, v73, v74 quad_perm:[1,1,1,1] row_mask:0xf bank_mask:0xf
    v_add_f32_dpp v79, v78, v79 quad_perm:[2,2,2,2] row_mask:0xf bank_mask:0xf
    v_cndmask_b32 v27, v27, v69, s[64:65]
    v_cndmask_b32 v27, v27, v74, s[66:67]
    v_cndmask_b32 v27, v27, v79, s[68:69]
    s_waitcnt vmcnt(5)
    buffer_load_dwordx4 v[180:183], v3, s[36:39], s59 offen offset:1024 nt
    v_mfma_f32_16x16x32_bf16 v[64:67], a[208:211], v[40:43], 0
    v_mfma_f32_16x16x32_bf16 v[68:71], a[212:215], v[40:43], 0
    v_mfma_f32_16x16x32_bf16 v[72:75], a[216:219], v[40:43], 0
    v_mfma_f32_16x16x32_bf16 v[76:79], a[220:223], v[40:43], 0
    v_add_f32_dpp v48, v49, v48 quad_perm:[1,1,1,1] row_mask:0xf bank_mask:0xf
    v_add_f32_dpp v53, v54, v53 quad_perm:[2,2,2,2] row_mask:0xf bank_mask:0xf
    v_add_f32_dpp v58, v59, v58 quad_perm:[3,3,3,3] row_mask:0xf bank_mask:0xf
    v_add_f32_dpp v63, v60, v63 quad_perm:[0,0,0,0] row_mask:0xf bank_mask:0xf
    v_add_f32_dpp v48, v50, v48 quad_perm:[2,2,2,2] row_mask:0xf bank_mask:0xf
    v_add_f32_dpp v53, v55, v53 quad_perm:[3,3,3,3] row_mask:0xf bank_mask:0xf
    v_add_f32_dpp v58, v56, v58 quad_perm:[0,0,0,0] row_mask:0xf bank_mask:0xf
    v_add_f32_dpp v63, v61, v63 quad_perm:[1,1,1,1] row_mask:0xf bank_mask:0xf
    v_add_f32_dpp v28, v51, v48 quad_perm:[3,3,3,3] row_mask:0xf bank_mask:0xf
    v_add_f32_dpp v53, v52, v53 quad_perm:[0,0,0,0] row_mask:0xf bank_mask:0xf
    v_add_f32_dpp v58, v57, v58 quad_perm:[1,1,1,1] row_mask:0xf bank_mask:0xf
    v_add_f32_dpp v63, v62, v63 quad_perm:[2,2,2,2] row_mask:0xf bank_mask:0xf
    v_cndmask_b32 v28, v28, v53, s[64:65]
    v_cndmask_b32 v28, v28, v58, s[66:67]
    v_cndmask_b32 v28, v28, v63, s[68:69]
    v_mfma_f32_16x16x32_bf16 v[48:51], a[224:227], v[40:43], 0
    v_mfma_f32_16x16x32_bf16 v[52:55], a[228:231], v[40:43], 0
    v_mfma_f32_16x16x32_bf16 v[56:59], a[232:235], v[40:43], 0
    v_mfma_f32_16x16x32_bf16 v[60:63], a[236:239], v[40:43], 0
    v_add_f32_dpp v64, v65, v64 quad_perm:[1,1,1,1] row_mask:0xf bank_mask:0xf
    v_add_f32_dpp v69, v70, v69 quad_perm:[2,2,2,2] row_mask:0xf bank_mask:0xf
    v_add_f32_dpp v74, v75, v74 quad_perm:[3,3,3,3] row_mask:0xf bank_mask:0xf
    v_add_f32_dpp v79, v76, v79 quad_perm:[0,0,0,0] row_mask:0xf bank_mask:0xf
    v_add_f32_dpp v64, v66, v64 quad_perm:[2,2,2,2] row_mask:0xf bank_mask:0xf
    v_add_f32_dpp v69, v71, v69 quad_perm:[3,3,3,3] row_mask:0xf bank_mask:0xf
    v_add_f32_dpp v74, v72, v74 quad_perm:[0,0,0,0] row_mask:0xf bank_mask:0xf
    v_add_f32_dpp v79, v77, v79 quad_perm:[1,1,1,1] row_mask:0xf bank_mask:0xf
    v_add_f32_dpp v29, v67, v64 quad_perm:[3,3,3,3] row_mask:0xf bank_mask:0xf
    v_add_f32_dpp v69, v68, v69 quad_perm:[0,0,0,0] row_mask:0xf bank_mask:0xf
    v_add_f32_dpp v74, v73, v74 quad_perm:[1,1,1,1] row_mask:0xf bank_mask:0xf
    v_add_f32_dpp v79, v78, v79 quad_perm:[2,2,2,2] row_mask:0xf bank_mask:0xf
    v_cndmask_b32 v29, v29, v69, s[64:65]
    v_cndmask_b32 v29, v29, v74, s[66:67]
    v_cndmask_b32 v29, v29, v79, s[68:69]
    s_waitcnt vmcnt(5)
    buffer_load_dwordx4 v[184:187], v3, s[36:39], s59 offen offset:2048 nt
    v_mfma_f32_16x16x32_bf16 v[64:67], a[240:243], v[40:43], 0
    v_mfma_f32_16x16x32_bf16 v[68:71], a[244:247], v[40:43], 0
    v_mfma_f32_16x16x32_bf16 v[72:75], a[248:251], v[40:43], 0
    v_mfma_f32_16x16x32_bf16 v[76:79], a[252:255], v[40:43], 0
    v_add_f32_dpp v48, v49, v48 quad_perm:[1,1,1,1] row_mask:0xf bank_mask:0xf
    v_add_f32_dpp v53, v54, v53 quad_perm:[2,2,2,2] row_mask:0xf bank_mask:0xf
    v_add_f32_dpp v58, v59, v58 quad_perm:[3,3,3,3] row_mask:0xf bank_mask:0xf
    v_add_f32_dpp v63, v60, v63 quad_perm:[0,0,0,0] row_mask:0xf bank_mask:0xf
    v_add_f32_dpp v48, v50, v48 quad_perm:[2,2,2,2] row_mask:0xf bank_mask:0xf
    v_add_f32_dpp v53, v55, v53 quad_perm:[3,3,3,3] row_mask:0xf bank_mask:0xf
    v_add_f32_dpp v58, v56, v58 quad_perm:[0,0,0,0] row_mask:0xf bank_mask:0xf
    v_add_f32_dpp v63, v61, v63 quad_perm:[1,1,1,1] row_mask:0xf bank_mask:0xf
    v_add_f32_dpp v30, v51, v48 quad_perm:[3,3,3,3] row_mask:0xf bank_mask:0xf
    v_add_f32_dpp v53, v52, v53 quad_perm:[0,0,0,0] row_mask:0xf bank_mask:0xf
    v_add_f32_dpp v58, v57, v58 quad_perm:[1,1,1,1] row_mask:0xf bank_mask:0xf
    v_add_f32_dpp v63, v62, v63 quad_perm:[2,2,2,2] row_mask:0xf bank_mask:0xf
    v_cndmask_b32 v30, v30, v53, s[64:65]
    v_cndmask_b32 v30, v30, v58, s[66:67]
    v_cndmask_b32 v30, v30, v63, s[68:69]
    v_add_f32_dpp v64, v65, v64 quad_perm:[1,1,1,1] row_mask:0xf bank_mask:0xf
    v_add_f32_dpp v69, v70, v69 quad_perm:[2,2,2,2] row_mask:0xf bank_mask:0xf
    v_add_f32_dpp v74, v75, v74 quad_perm:[3,3,3,3] row_mask:0xf bank_mask:0xf
    v_add_f32_dpp v79, v76, v79 quad_perm:[0,0,0,0] row_mask:0xf bank_mask:0xf
    v_add_f32_dpp v64, v66, v64 quad_perm:[2,2,2,2] row_mask:0xf bank_mask:0xf
    v_add_f32_dpp v69, v71, v69 quad_perm:[3,3,3,3] row_mask:0xf bank_mask:0xf
    v_add_f32_dpp v74, v72, v74 quad_perm:[0,0,0,0] row_mask:0xf bank_mask:0xf
    v_add_f32_dpp v79, v77, v79 quad_perm:[1,1,1,1] row_mask:0xf bank_mask:0xf
    v_add_f32_dpp v31, v67, v64 quad_perm:[3,3,3,3] row_mask:0xf bank_mask:0xf
    v_add_f32_dpp v69, v68, v69 quad_perm:[0,0,0,0] row_mask:0xf bank_mask:0xf
    v_add_f32_dpp v74, v73, v74 quad_perm:[1,1,1,1] row_mask:0xf bank_mask:0xf
    v_add_f32_dpp v79, v78, v79 quad_perm:[2,2,2,2] row_mask:0xf bank_mask:0xf
    v_cndmask_b32 v31, v31, v69, s[64:65]
    v_cndmask_b32 v31, v31, v74, s[66:67]
    v_cndmask_b32 v31, v31, v79, s[68:69]
    s_waitcnt vmcnt(5)
    buffer_load_dwordx4 v[188:191], v3, s[36:39], s59 offen offset:3072 nt
    v_cvt_pk_bf16_f32 v48, v16, v17
    v_cvt_pk_bf16_f32 v49, v18, v19
    v_cvt_pk_bf16_f32 v50, v20, v21
    v_cvt_pk_bf16_f32 v51, v22, v23
    v_cvt_pk_bf16_f32 v52, v24, v25
    v_cvt_pk_bf16_f32 v53, v26, v27
    v_cvt_pk_bf16_f32 v54, v28, v29
    v_cvt_pk_bf16_f32 v55, v30, v31
    v_lshlrev_b32 v16, 16, v48
    v_and_b32 v17, 0xffff0000, v48
    v_lshlrev_b32 v18, 16, v49
    v_and_b32 v19, 0xffff0000, v49
    v_lshlrev_b32 v20, 16, v50
    v_and_b32 v21, 0xffff0000, v50
    v_lshlrev_b32 v22, 16, v51
    v_and_b32 v23, 0xffff0000, v51
    v_lshlrev_b32 v24, 16, v52
    v_and_b32 v25, 0xffff0000, v52
    v_lshlrev_b32 v26, 16, v53
    v_and_b32 v27, 0xffff0000, v53
    v_lshlrev_b32 v28, 16, v54
    v_and_b32 v29, 0xffff0000, v54
    v_lshlrev_b32 v30, 16, v55
    v_and_b32 v31, 0xffff0000, v55
    v_mul_f32 v16, 0x3db504f3, v16
    v_mul_f32 v17, 0x3db504f3, v17
    v_mul_f32 v18, 0x3db504f3, v18
    v_mul_f32 v19, 0x3db504f3, v19
    v_mul_f32 v20, 0x3db504f3, v20
    v_mul_f32 v21, 0x3db504f3, v21
    v_mul_f32 v22, 0x3db504f3, v22
    v_mul_f32 v23, 0x3db504f3, v23
    v_mul_f32 v24, 0x3db504f3, v24
    v_mul_f32 v25, 0x3db504f3, v25
    v_mul_f32 v26, 0x3db504f3, v26
    v_mul_f32 v27, 0x3db504f3, v27
    v_mul_f32 v28, 0x3db504f3, v28
    v_mul_f32 v29, 0x3db504f3, v29
    v_mul_f32 v30, 0x3db504f3, v30
    v_mul_f32 v31, 0x3db504f3, v31
    s_mov_b32 s59, 98304
    s_waitcnt vmcnt(5)
    buffer_load_dwordx4 v[192:195], v3, s[36:39], s59 offen offset:0 nt
    v_cvt_pk_bf16_f32 v48, v16, v17
    v_cvt_pk_bf16_f32 v49, v18, v19
    v_cvt_pk_bf16_f32 v50, v20, v21
    v_cvt_pk_bf16_f32 v51, v22, v23
    v_cvt_pk_bf16_f32 v52, v24, v25
    v_cvt_pk_bf16_f32 v53, v26, v27
    v_cvt_pk_bf16_f32 v54, v28, v29
    v_cvt_pk_bf16_f32 v55, v30, v31
    v_lshlrev_b32 v16, 16, v48
    v_and_b32 v17, 0xffff0000, v48
    v_lshlrev_b32 v18, 16, v49
    v_and_b32 v19, 0xffff0000, v49
    v_lshlrev_b32 v20, 16, v50
    v_and_b32 v21, 0xffff0000, v50
    v_lshlrev_b32 v22, 16, v51
    v_and_b32 v23, 0xffff0000, v51
    v_lshlrev_b32 v24, 16, v52
    v_and_b32 v25, 0xffff0000, v52
    v_lshlrev_b32 v26, 16, v53
    v_and_b32 v27, 0xffff0000, v53
    v_lshlrev_b32 v28, 16, v54
    v_and_b32 v29, 0xffff0000, v54
    v_lshlrev_b32 v30, 16, v55
    v_and_b32 v31, 0xffff0000, v55
    v_max3_f32 v48, v16, v17, v18
    v_max3_f32 v48, v48, v19, v20
    v_max3_f32 v48, v48, v21, v22
    v_max3_f32 v48, v48, v23, v24
    v_max3_f32 v48, v48, v25, v26
    v_max3_f32 v48, v48, v27, v28
    v_max3_f32 v48, v48, v29, v30
    v_max_f32 v48, v48, v31
    s_nop 1
    v_max_f32_dpp v48, v48, v48 quad_perm:[1,0,3,2] row_mask:0xf bank_mask:0xf
    s_nop 1
    v_max_f32_dpp v48, v48, v48 quad_perm:[2,3,0,1] row_mask:0xf bank_mask:0xf
    v_mov_b32 v49, v48
    s_nop 1
    v_permlane16_swap_b32 v48, v49
    v_max_f32 v48, v48, v49
    v_mov_b32 v49, v48
    s_nop 1
    v_permlane32_swap_b32 v48, v49
    v_max_f32 v48, v48, v49
    v_mul_f32 v48, s72, v48
    v_fma_f32 v16, v16, s72, -v48
    v_fma_f32 v17, v17, s72, -v48
    v_fma_f32 v18, v18, s72, -v48
    v_fma_f32 v19, v19, s72, -v48
    v_fma_f32 v20, v20, s72, -v48
    v_fma_f32 v21, v21, s72, -v48
    v_fma_f32 v22, v22, s72, -v48
    v_fma_f32 v23, v23, s72, -v48
    v_fma_f32 v24, v24, s72, -v48
    v_fma_f32 v25, v25, s72, -v48
    v_fma_f32 v26, v26, s72, -v48
    v_fma_f32 v27, v27, s72, -v48
    v_fma_f32 v28, v28, s72, -v48
    v_fma_f32 v29, v29, s72, -v48
    v_fma_f32 v30, v30, s72, -v48
    v_fma_f32 v31, v31, s72, -v48
    s_waitcnt vmcnt(5)
    buffer_load_dwordx4 v[196:199], v3, s[36:39], s59 offen offset:1024 nt
    v_exp_f32 v16, v16
    v_exp_f32 v17, v17
    v_exp_f32 v18, v18
    v_exp_f32 v19, v19
    v_exp_f32 v20, v20
    v_exp_f32 v21, v21
    v_exp_f32 v22, v22
    v_exp_f32 v23, v23
    v_exp_f32 v24, v24
    v_exp_f32 v25, v25
    v_exp_f32 v26, v26
    v_exp_f32 v27, v27
    v_exp_f32 v28, v28
    v_exp_f32 v29, v29
    v_exp_f32 v30, v30
    v_exp_f32 v31, v31
    v_add_f32 v52, v16, v17
    v_add_f32 v53, v18, v19
    v_add_f32 v54, v20, v21
    v_add_f32 v55, v22, v23
    v_add_f32 v56, v24, v25
    v_add_f32 v57, v26, v27
    v_add_f32 v58, v28, v29
    v_add_f32 v59, v30, v31
    v_add_f32 v52, v52, v56
    v_add_f32 v53, v53, v57
    v_add_f32 v54, v54, v58
    v_add_f32 v55, v55, v59
    v_add_f32 v52, v52, v54
    v_add_f32 v53, v53, v55
    v_add_f32 v49, v52, v53
    s_waitcnt vmcnt(5)
    buffer_load_dwordx4 v[200:203], v3, s[36:39], s59 offen offset:2048 nt
    v_add_f32_dpp v49, v49, v49 quad_perm:[1,0,3,2] row_mask:0xf bank_mask:0xf
    s_nop 1
    v_add_f32_dpp v49, v49, v49 quad_perm:[2,3,0,1] row_mask:0xf bank_mask:0xf
    v_mov_b32 v50, v49
    s_nop 1
    v_permlane16_swap_b32 v49, v50
    v_add_f32 v49, v49, v50
    v_mov_b32 v50, v49
    s_nop 1
    v_permlane32_swap_b32 v49, v50
    v_add_f32 v49, v49, v50
    s_lshl_b32 s61, s52, 9
    s_add_u32 s61, s61, 90368
    v_lshl_add_u32 v50, v1, 3, s61
    v_lshlrev_b32 v51, 3, v1
    v_add_u32 v51, 90368, v51
    ds_write_b64 v50, v[48:49]
    s_waitcnt vmcnt(5)
    buffer_load_dwordx4 v[204:207], v3, s[36:39], s59 offen offset:3072 nt
    s_waitcnt lgkmcnt(0)
    s_barrier
    ds_read_b64 v[52:53], v51 offset:0
    ds_read_b64 v[54:55], v51 offset:512
    ds_read_b64 v[56:57], v51 offset:1024
    ds_read_b64 v[58:59], v51 offset:1536
    v_lshrrev_b32 v4, 4, v1
    v_lshlrev_b32 v4, 5, v4
    v_bfe_u32 v6, v1, 3, 1
    v_lshl_add_u32 v4, v6, 3, v4
    v_bfe_u32 v6, v1, 2, 1
    v_add_u32 v4, v4, v6
    v_lshlrev_b32 v4, 7, v4
    v_and_b32 v6, 3, v1
    v_lshl_add_u32 v4, v6, 3, v4
    s_and_b32 s61, s52, 2
    v_bfe_u32 v6, v1, 3, 2
    v_xor_b32 v6, s61, v6
    v_lshl_add_u32 v4, v6, 5, v4
    v_add_u32 v4, 65536, v4
    v_xor_b32 v13, 32, v4
    s_mov_b32 s59, 114688
    s_waitcnt vmcnt(5)
    buffer_load_dwordx4 v[208:211], v3, s[36:39], s59 offen offset:0 nt
    s_waitcnt lgkmcnt(0)
    v_max3_f32 v60, v52, v54, v56
    v_max_f32 v60, v60, v58
    v_sub_f32 v48, v48, v60
    v_exp_f32 v48, v48
    v_sub_f32 v52, v52, v60
    v_sub_f32 v54, v54, v60
    v_sub_f32 v56, v56, v60
    v_sub_f32 v58, v58, v60
    v_exp_f32 v52, v52
    v_exp_f32 v54, v54
    v_exp_f32 v56, v56
    v_exp_f32 v58, v58
    v_mul_f32 v62, v52, v53
    v_fmac_f32 v62, v54, v55
    v_fmac_f32 v62, v56, v57
    v_fmac_f32 v62, v58, v59
    s_cmp_eq_u32 s52, 2
    s_cbranch_scc0 L_ml_done
    v_mov_b32 v61, s58
    v_mov_b32 v63, s58
    v_writelane_b32 v60, s56, 16
    s_lshl_b32 s61, s77, 7
    s_add_u32 s61, s61, 262144
    v_lshl_add_u32 v5, v1, 2, s61
    s_mov_b64 exec, 0x11111
    buffer_store_dwordx4 v[60:63], v5, s[48:51], 0 offen
    s_mov_b64 exec, -1
L_ml_done:
    v_mul_f32 v16, v16, v48
    v_mul_f32 v17, v17, v48
    v_mul_f32 v18, v18, v48
    v_mul_f32 v19, v19, v48
    v_mul_f32 v20, v20, v48
    v_mul_f32 v21, v21, v48
    v_mul_f32 v22, v22, v48
    v_mul_f32 v23, v23, v48
    v_mul_f32 v24, v24, v48
    v_mul_f32 v25, v25, v48
    v_mul_f32 v26, v26, v48
    v_mul_f32 v27, v27, v48
    v_mul_f32 v28, v28, v48
    v_mul_f32 v29, v29, v48
    v_mul_f32 v30, v30, v48
    v_mul_f32 v31, v31, v48
    v_cvt_pk_bf16_f32 v32, v16, v17
    v_cvt_pk_bf16_f32 v33, v18, v19
    v_cvt_pk_bf16_f32 v34, v20, v21
    v_cvt_pk_bf16_f32 v35, v22, v23
    v_cvt_pk_bf16_f32 v36, v24, v25
    v_cvt_pk_bf16_f32 v37, v26, v27
    v_cvt_pk_bf16_f32 v38, v28, v29
    v_cvt_pk_bf16_f32 v39, v30, v31
    s_waitcnt vmcnt(5)
    buffer_load_dwordx4 v[212:215], v3, s[36:39], s59 offen offset:1024 nt
    s_and_b32 s61, s52, 1
    s_lshl_b32 s61, s61, 4
    s_lshl_b32 s62, s53, 5
    s_add_u32 s61, s61, s62
    v_lshrrev_b32 v6, 4, v1
    v_and_b32 v7, 15, v1
    s_lshl_b32 s62, s53, 15
    s_add_u32 s76, s62, 327680
    s_lshl_b32 s62, s55, 13
    s_and_b32 s63, s52, 1
    s_lshl_b32 s63, s63, 12
    s_add_u32 s62, s62, s63
    s_add_u32 s62, s62, s76
    v_lshl_add_u32 v24, v1, 4, s62
    s_lshr_b32 s62, s57, 4
    s_lshl_b32 s62, s62, 12
    s_lshl_b32 s63, s52, 10
    s_add_u32 s62, s62, s63
    s_and_b32 s63, s57, 15
    s_lshl_b32 s63, s63, 4
    s_add_u32 s62, s62, s63
    s_add_u32 s62, s62, s76
    v_lshlrev_b32 v8, 13, v6
    v_bfe_u32 v7, v1, 2, 2
    v_lshl_add_u32 v8, v7, 8, v8
    v_and_b32 v7, 3, v1
    v_lshl_add_u32 v8, v7, 2, v8
    v_add_u32 v8, s62, v8
    s_lshl_b32 s62, s61, 7
    s_lshl_b32 s63, s55, 4
    s_add_u32 s62, s62, s63
    s_add_u32 s62, s62, 262144
    v_lshl_add_u32 v30, v6, 9, s62
    s_lshl_b32 s62, s53, 12
    s_add_u32 s62, s62, 262208
    v_and_b32 v29, 31, v1
    v_lshl_add_u32 v29, v29, 7, s62
    s_and_b32 s61, s52, 1
    s_lshl_b32 s61, s61, 15
    s_lshl_b32 s62, s54, 16
    s_add_u32 s61, s61, s62
    s_lshr_b32 s62, s52, 1
    s_lshl_b32 s62, s62, 12
    s_add_u32 s61, s61, s62
    s_lshl_b32 s62, s78, 7
    s_add_u32 s61, s61, s62
    s_add_u32 s61, s61, 1048576
    v_lshlrev_b32 v25, 13, v6
    v_and_b32 v7, 15, v1
    v_lshl_add_u32 v25, v7, 3, v25
    v_add_u32 v25, s61, v25
    s_lshr_b32 s61, s77, 1
    s_lshl_b32 s61, s61, 12
    s_and_b32 s62, s55, 1
    s_lshl_b32 s62, s62, 6
    s_add_u32 s61, s61, s62
    s_add_u32 s61, s61, 1048576
    v_lshrrev_b32 v26, 2, v1
    v_lshlrev_b32 v26, 7, v26
    v_and_b32 v7, 3, v1
    v_lshl_add_u32 v26, v7, 4, v26
    v_add_u32 v26, s61, v26
    s_lshl_b32 s61, s52, 11
    s_add_u32 s61, s61, 94208
    v_lshl_add_u32 v27, v1, 2, s61
    s_lshl_b32 s61, s52, 9
    s_add_u32 s61, s61, 94208
    v_lshl_add_u32 v28, v1, 2, s61
    s_lshl_b32 s61, s53, 15
    s_lshl_b32 s62, s54, 9
    s_add_u32 s61, s61, s62
    s_add_u32 s61, s61, 589824
    v_bfe_u32 v31, v1, 2, 2
    v_lshlrev_b32 v31, 12, v31
    v_lshl_add_u32 v31, v12, 3, v31
    v_add_u32 v31, s61, v31
    s_lshl_b32 s61, s54, 10
    s_lshl_b32 s62, s53, 7
    s_add_u32 s61, s61, s62
    v_lshl_add_u32 v12, v12, 1, s61
    s_and_b32 s75, s58, 0x3ff
    s_waitcnt vmcnt(5)
    buffer_load_dwordx4 v[216:219], v3, s[36:39], s59 offen offset:2048 nt
    v_mov_b32_dpp v44, v32 quad_perm:[0,0,0,0] row_mask:0xf bank_mask:0xf
    v_mov_b32_dpp v45, v32 quad_perm:[1,1,1,1] row_mask:0xf bank_mask:0xf
    v_mov_b32_dpp v46, v32 quad_perm:[2,2,2,2] row_mask:0xf bank_mask:0xf
    v_mov_b32_dpp v47, v32 quad_perm:[3,3,3,3] row_mask:0xf bank_mask:0xf
    s_waitcnt vmcnt(26)
    v_perm_b32 v48, v112, v96, s70
    v_perm_b32 v52, v112, v96, s71
    v_perm_b32 v56, v113, v97, s70
    v_perm_b32 v60, v113, v97, s71
    v_perm_b32 v64, v114, v98, s70
    v_perm_b32 v68, v114, v98, s71
    v_perm_b32 v72, v115, v99, s70
    v_perm_b32 v76, v115, v99, s71
    s_waitcnt vmcnt(25)
    v_perm_b32 v49, v116, v100, s70
    v_perm_b32 v53, v116, v100, s71
    v_perm_b32 v57, v117, v101, s70
    v_perm_b32 v61, v117, v101, s71
    v_perm_b32 v65, v118, v102, s70
    v_perm_b32 v69, v118, v102, s71
    v_perm_b32 v73, v119, v103, s70
    v_perm_b32 v77, v119, v103, s71
    s_waitcnt vmcnt(24)
    v_perm_b32 v50, v120, v104, s70
    v_perm_b32 v54, v120, v104, s71
    v_perm_b32 v58, v121, v105, s70
    v_perm_b32 v62, v121, v105, s71
    v_perm_b32 v66, v122, v106, s70
    v_perm_b32 v70, v122, v106, s71
    v_perm_b32 v74, v123, v107, s70
    v_perm_b32 v78, v123, v107, s71
    s_waitcnt vmcnt(23)
    v_perm_b32 v51, v124, v108, s70
    v_perm_b32 v55, v124, v108, s71
    v_perm_b32 v59, v125, v109, s70
    v_mfma_f32_16x16x32_bf16 a[32:35], v[44:47], v[48:51], 0
    v_perm_b32 v63, v125, v109, s71
    v_mfma_f32_16x16x32_bf16 a[36:39], v[44:47], v[52:55], 0
    v_perm_b32 v67, v126, v110, s70
    v_mfma_f32_16x16x32_bf16 a[40:43], v[44:47], v[56:59], 0
    v_perm_b32 v71, v126, v110, s71
    v_mfma_f32_16x16x32_bf16 a[44:47], v[44:47], v[60:63], 0
    v_perm_b32 v75, v127, v111, s70
    v_mfma_f32_16x16x32_bf16 a[48:51], v[44:47], v[64:67], 0
    v_perm_b32 v79, v127, v111, s71
    v_mfma_f32_16x16x32_bf16 a[52:55], v[44:47], v[68:71], 0
    v_mfma_f32_16x16x32_bf16 a[56:59], v[44:47], v[72:75], 0
    v_mfma_f32_16x16x32_bf16 a[60:63], v[44:47], v[76:79], 0
    v_mov_b32_dpp v44, v33 quad_perm:[0,0,0,0] row_mask:0xf bank_mask:0xf
    v_mov_b32_dpp v45, v33 quad_perm:[1,1,1,1] row_mask:0xf bank_mask:0xf
    v_mov_b32_dpp v46, v33 quad_perm:[2,2,2,2] row_mask:0xf bank_mask:0xf
    v_mov_b32_dpp v47, v33 quad_perm:[3,3,3,3] row_mask:0xf bank_mask:0xf
    s_waitcnt vmcnt(18)
    v_perm_b32 v48, v144, v128, s70
    v_perm_b32 v52, v144, v128, s71
    v_perm_b32 v56, v145, v129, s70
    v_perm_b32 v60, v145, v129, s71
    v_perm_b32 v64, v146, v130, s70
    v_perm_b32 v68, v146, v130, s71
    v_perm_b32 v72, v147, v131, s70
    v_perm_b32 v76, v147, v131, s71
    s_waitcnt vmcnt(17)
    v_perm_b32 v49, v148, v132, s70
    v_perm_b32 v53, v148, v132, s71
    v_perm_b32 v57, v149, v133, s70
    v_perm_b32 v61, v149, v133, s71
    v_perm_b32 v65, v150, v134, s70
    v_perm_b32 v69, v150, v134, s71
    v_perm_b32 v73, v151, v135, s70
    v_perm_b32 v77, v151, v135, s71
    s_waitcnt vmcnt(16)
    v_perm_b32 v50, v152, v136, s70
    v_perm_b32 v54, v152, v136, s71
    v_perm_b32 v58, v153, v137, s70
    v_perm_b32 v62, v153, v137, s71
    v_perm_b32 v66, v154, v138, s70
    v_perm_b32 v70, v154, v138, s71
    v_perm_b32 v74, v155, v139, s70
    v_perm_b32 v78, v155, v139, s71
    s_waitcnt vmcnt(15)
    v_perm_b32 v51, v156, v140, s70
    v_perm_b32 v55, v156, v140, s71
    v_perm_b32 v59, v157, v141, s70
    v_mfma_f32_16x16x32_bf16 a[32:35], v[44:47], v[48:51], a[32:35]
    v_perm_b32 v63, v157, v141, s71
    v_mfma_f32_16x16x32_bf16 a[36:39], v[44:47], v[52:55], a[36:39]
    v_perm_b32 v67, v158, v142, s70
    v_mfma_f32_16x16x32_bf16 a[40:43], v[44:47], v[56:59], a[40:43]
    v_perm_b32 v71, v158, v142, s71
    v_mfma_f32_16x16x32_bf16 a[44:47], v[44:47], v[60:63], a[44:47]
    v_perm_b32 v75, v159, v143, s70
    v_mfma_f32_16x16x32_bf16 a[48:51], v[44:47], v[64:67], a[48:51]
    v_perm_b32 v79, v159, v143, s71
    v_mfma_f32_16x16x32_bf16 a[52:55], v[44:47], v[68:71], a[52:55]
    v_mfma_f32_16x16x32_bf16 a[56:59], v[44:47], v[72:75], a[56:59]
    v_mfma_f32_16x16x32_bf16 a[60:63], v[44:47], v[76:79], a[60:63]
    v_mov_b32_dpp v44, v34 quad_perm:[0,0,0,0] row_mask:0xf bank_mask:0xf
    v_mov_b32_dpp v45, v34 quad_perm:[1,1,1,1] row_mask:0xf bank_mask:0xf
    v_mov_b32_dpp v46, v34 quad_perm:[2,2,2,2] row_mask:0xf bank_mask:0xf
    v_mov_b32_dpp v47, v34 quad_perm:[3,3,3,3] row_mask:0xf bank_mask:0xf
    s_waitcnt vmcnt(10)
    v_perm_b32 v48, v176, v160, s70
    v_perm_b32 v52, v176, v160, s71
    v_perm_b32 v56, v177, v161, s70
    v_perm_b32 v60, v177, v161, s71
    v_perm_b32 v64, v178, v162, s70
    v_perm_b32 v68, v178, v162, s71
    v_perm_b32 v72, v179, v163, s70
    v_perm_b32 v76, v179, v163, s71
    s_waitcnt vmcnt(9)
    v_perm_b32 v49, v180, v164, s70
    v_perm_b32 v53, v180, v164, s71
    v_perm_b32 v57, v181, v165, s70
    v_perm_b32 v61, v181, v165, s71
    v_perm_b32 v65, v182, v166, s70
    v_perm_b32 v69, v182, v166, s71
    v_perm_b32 v73, v183, v167, s70
    v_perm_b32 v77, v183, v167, s71
    s_waitcnt vmcnt(8)
    v_perm_b32 v50, v184, v168, s70
    v_perm_b32 v54, v184, v168, s71
    v_perm_b32 v58, v185, v169, s70
    v_perm_b32 v62, v185, v169, s71
    v_perm_b32 v66, v186, v170, s70
    v_perm_b32 v70, v186, v170, s71
    v_perm_b32 v74, v187, v171, s70
    v_perm_b32 v78, v187, v171, s71
    s_waitcnt vmcnt(7)
    v_perm_b32 v51, v188, v172, s70
    v_perm_b32 v55, v188, v172, s71
    v_perm_b32 v59, v189, v173, s70
    v_mfma_f32_16x16x32_bf16 a[32:35], v[44:47], v[48:51], a[32:35]
    v_perm_b32 v63, v189, v173, s71
    v_mfma_f32_16x16x32_bf16 a[36:39], v[44:47], v[52:55], a[36:39]
    v_perm_b32 v67, v190, v174, s70
    v_mfma_f32_16x16x32_bf16 a[40:43], v[44:47], v[56:59], a[40:43]
    v_perm_b32 v71, v190, v174, s71
    v_mfma_f32_16x16x32_bf16 a[44:47], v[44:47], v[60:63], a[44:47]
    v_perm_b32 v75, v191, v175, s70
    v_mfma_f32_16x16x32_bf16 a[48:51], v[44:47], v[64:67], a[48:51]
    v_perm_b32 v79, v191, v175, s71
    v_mfma_f32_16x16x32_bf16 a[52:55], v[44:47], v[68:71], a[52:55]
    v_mfma_f32_16x16x32_bf16 a[56:59], v[44:47], v[72:75], a[56:59]
    v_mfma_f32_16x16x32_bf16 a[60:63], v[44:47], v[76:79], a[60:63]
    s_waitcnt vmcnt(5)
    buffer_load_dwordx4 v[220:223], v3, s[36:39], s59 offen offset:3072 nt
    s_mov_b32 s59, 131072
    s_waitcnt vmcnt(5)
    buffer_load_dwordx4 v[224:227], v3, s[36:39], s59 offen offset:0 nt
    s_waitcnt vmcnt(5)
    buffer_load_dwordx4 v[228:231], v3, s[36:39], s59 offen offset:1024 nt
    s_waitcnt vmcnt(5)
    buffer_load_dwordx4 v[232:235], v3, s[36:39], s59 offen offset:2048 nt
    v_mov_b32_dpp v44, v35 quad_perm:[0,0,0,0] row_mask:0xf bank_mask:0xf
    v_mov_b32_dpp v45, v35 quad_perm:[1,1,1,1] row_mask:0xf bank_mask:0xf
    v_mov_b32_dpp v46, v35 quad_perm:[2,2,2,2] row_mask:0xf bank_mask:0xf
    v_mov_b32_dpp v47, v35 quad_perm:[3,3,3,3] row_mask:0xf bank_mask:0xf
    s_waitcnt vmcnt(6)
    v_perm_b32 v48, v208, v192, s70
    v_perm_b32 v52, v208, v192, s71
    v_perm_b32 v56, v209, v193, s70
    v_perm_b32 v60, v209, v193, s71
    v_perm_b32 v64, v210, v194, s70
    v_perm_b32 v68, v210, v194, s71
    v_perm_b32 v72, v211, v195, s70
    v_perm_b32 v76, v211, v195, s71
    s_waitcnt vmcnt(5)
    buffer_load_dwordx4 v[236:239], v3, s[36:39], s59 offen offset:3072 nt
    s_waitcnt vmcnt(6)
    v_perm_b32 v49, v212, v196, s70
    v_perm_b32 v53, v212, v196, s71
    v_perm_b32 v57, v213, v197, s70
    v_perm_b32 v61, v213, v197, s71
    v_perm_b32 v65, v214, v198, s70
    v_perm_b32 v69, v214, v198, s71
    v_perm_b32 v73, v215, v199, s70
    v_perm_b32 v77, v215, v199, s71
    s_mov_b32 s59, 147456
    s_waitcnt vmcnt(5)
    buffer_load_dwordx4 v[240:243], v3, s[36:39], s59 offen offset:0 nt
    s_waitcnt vmcnt(6)
    v_perm_b32 v50, v216, v200, s70
    v_perm_b32 v54, v216, v200, s71
    v_perm_b32 v58, v217, v201, s70
    v_perm_b32 v62, v217, v201, s71
    v_perm_b32 v66, v218, v202, s70
    v_perm_b32 v70, v218, v202, s71
    v_perm_b32 v74, v219, v203, s70
    v_perm_b32 v78, v219, v203, s71
    s_waitcnt vmcnt(5)
    buffer_load_dwordx4 v[244:247], v3, s[36:39], s59 offen offset:1024 nt
    s_waitcnt vmcnt(6)
    v_perm_b32 v51, v220, v204, s70
    v_perm_b32 v55, v220, v204, s71
    v_perm_b32 v59, v221, v205, s70
    v_mfma_f32_16x16x32_bf16 a[32:35], v[44:47], v[48:51], a[32:35]
    v_perm_b32 v63, v221, v205, s71
    v_mfma_f32_16x16x32_bf16 a[36:39], v[44:47], v[52:55], a[36:39]
    v_perm_b32 v67, v222, v206, s70
    v_mfma_f32_16x16x32_bf16 a[40:43], v[44:47], v[56:59], a[40:43]
    v_perm_b32 v71, v222, v206, s71
    v_mfma_f32_16x16x32_bf16 a[44:47], v[44:47], v[60:63], a[44:47]
    v_perm_b32 v75, v223, v207, s70
    v_mfma_f32_16x16x32_bf16 a[48:51], v[44:47], v[64:67], a[48:51]
    v_perm_b32 v79, v223, v207, s71
    v_mfma_f32_16x16x32_bf16 a[52:55], v[44:47], v[68:71], a[52:55]
    v_mfma_f32_16x16x32_bf16 a[56:59], v[44:47], v[72:75], a[56:59]
    v_mfma_f32_16x16x32_bf16 a[60:63], v[44:47], v[76:79], a[60:63]
    s_waitcnt vmcnt(5)
    buffer_load_dwordx4 v[248:251], v3, s[36:39], s59 offen offset:2048 nt
    s_waitcnt vmcnt(5)
    buffer_load_dwordx4 v[252:255], v3, s[36:39], s59 offen offset:3072 nt
    s_mov_b32 s59, 163840
    s_waitcnt vmcnt(5)
    buffer_load_dwordx4 v[96:99], v3, s[36:39], s59 offen offset:0 nt
    s_waitcnt vmcnt(5)
    buffer_load_dwordx4 v[100:103], v3, s[36:39], s59 offen offset:1024 nt
    s_waitcnt vmcnt(5)
    buffer_load_dwordx4 v[104:107], v3, s[36:39], s59 offen offset:2048 nt
    v_mov_b32_dpp v44, v36 quad_perm:[0,0,0,0] row_mask:0xf bank_mask:0xf
    v_mov_b32_dpp v45, v36 quad_perm:[1,1,1,1] row_mask:0xf bank_mask:0xf
    v_mov_b32_dpp v46, v36 quad_perm:[2,2,2,2] row_mask:0xf bank_mask:0xf
    v_mov_b32_dpp v47, v36 quad_perm:[3,3,3,3] row_mask:0xf bank_mask:0xf
    s_waitcnt vmcnt(6)
    v_perm_b32 v48, v240, v224, s70
    v_perm_b32 v52, v240, v224, s71
    v_perm_b32 v56, v241, v225, s70
    v_perm_b32 v60, v241, v225, s71
    v_perm_b32 v64, v242, v226, s70
    v_perm_b32 v68, v242, v226, s71
    v_perm_b32 v72, v243, v227, s70
    v_perm_b32 v76, v243, v227, s71
    s_waitcnt vmcnt(5)
    buffer_load_dwordx4 v[108:111], v3, s[36:39], s59 offen offset:3072 nt
    s_waitcnt vmcnt(6)
    v_perm_b32 v49, v244, v228, s70
    v_perm_b32 v53, v244, v228, s71
    v_perm_b32 v57, v245, v229, s70
    v_perm_b32 v61, v245, v229, s71
    v_perm_b32 v65, v246, v230, s70
    v_perm_b32 v69, v246, v230, s71
    v_perm_b32 v73, v247, v231, s70
    v_perm_b32 v77, v247, v231, s71
    s_mov_b32 s59, 180224
    s_waitcnt vmcnt(5)
    buffer_load_dwordx4 v[112:115], v3, s[36:39], s59 offen offset:0 nt
    s_waitcnt vmcnt(6)
    v_perm_b32 v50, v248, v232, s70
    v_perm_b32 v54, v248, v232, s71
    v_perm_b32 v58, v249, v233, s70
    v_perm_b32 v62, v249, v233, s71
    v_perm_b32 v66, v250, v234, s70
    v_perm_b32 v70, v250, v234, s71
    v_perm_b32 v74, v251, v235, s70
    v_perm_b32 v78, v251, v235, s71
    s_waitcnt vmcnt(5)
    buffer_load_dwordx4 v[116:119], v3, s[36:39], s59 offen offset:1024 nt
    s_waitcnt vmcnt(6)
    v_perm_b32 v51, v252, v236, s70
    v_perm_b32 v55, v252, v236, s71
    v_perm_b32 v59, v253, v237, s70
    v_mfma_f32_16x16x32_bf16 a[32:35], v[44:47], v[48:51], a[32:35]
    v_perm_b32 v63, v253, v237, s71
    v_mfma_f32_16x16x32_bf16 a[36:39], v[44:47], v[52:55], a[36:39]
    v_perm_b32 v67, v254, v238, s70
    v_mfma_f32_16x16x32_bf16 a[40:43], v[44:47], v[56:59], a[40:43]
    v_perm_b32 v71, v254, v238, s71
    v_mfma_f32_16x16x32_bf16 a[44:47], v[44:47], v[60:63], a[44:47]
    v_perm_b32 v75, v255, v239, s70
    v_mfma_f32_16x16x32_bf16 a[48:51], v[44:47], v[64:67], a[48:51]
    v_perm_b32 v79, v255, v239, s71
    v_mfma_f32_16x16x32_bf16 a[52:55], v[44:47], v[68:71], a[52:55]
    v_mfma_f32_16x16x32_bf16 a[56:59], v[44:47], v[72:75], a[56:59]
    v_mfma_f32_16x16x32_bf16 a[60:63], v[44:47], v[76:79], a[60:63]
    s_waitcnt vmcnt(5)
    buffer_load_dwordx4 v[120:123], v3, s[36:39], s59 offen offset:2048 nt
    s_waitcnt vmcnt(5)
    buffer_load_dwordx4 v[124:127], v3, s[36:39], s59 offen offset:3072 nt
    s_mov_b32 s59, 196608
    s_waitcnt vmcnt(15)
    buffer_load_dwordx4 v[128:131], v3, s[36:39], s59 offen offset:0 nt
    s_waitcnt vmcnt(15)
    buffer_load_dwordx4 v[132:135], v3, s[36:39], s59 offen offset:1024 nt
    s_waitcnt vmcnt(15)
    buffer_load_dwordx4 v[136:139], v3, s[36:39], s59 offen offset:2048 nt
    s_waitcnt vmcnt(15)
    buffer_load_dwordx4 v[140:143], v3, s[36:39], s59 offen offset:3072 nt
    s_cmp_eq_u32 s52, 3
    s_cbranch_scc0 L_fg_done
    v_mov_b32 v18, 0
    v_mov_b32 v19, s58
    s_movk_i32 s61, 16384
    buffer_load_dwordx2 v[16:17], v31, s[48:51], 0 offen sc1
    s_and_b32 exec_lo, exec_lo, 0x0fff0fff
    s_and_b32 exec_hi, exec_hi, 0x0fff0fff
    s_cbranch_execz L_fg_skipFG
    buffer_load_dwordx2 v[18:19], v31, s[48:51], s61 offen sc1
L_fg_skipFG:
    s_mov_b64 exec, -1
    s_lshl_b32 s61, s54, 10
    v_lshl_add_u32 v5, v1, 4, s61
    global_load_dwordx4 v[208:211], v5, s[4:5]
    v_lshlrev_b32 v5, 4, v1
    global_load_dwordx4 v[212:215], v5, s[24:25]
    v_and_b32 v5, 0x3ff, v12
    global_load_ushort v11, v5, s[22:23]
L_fg_done:
    buffer_load_dwordx4 v[80:83], v30, s[48:51], 0 offen offset:0 sc1
    buffer_load_dwordx4 v[84:87], v30, s[48:51], 0 offen offset:128 sc1
    buffer_load_dwordx4 v[88:91], v30, s[48:51], 0 offen offset:256 sc1
    buffer_load_dwordx4 v[92:95], v30, s[48:51], 0 offen offset:384 sc1
    buffer_load_dwordx2 v[20:21], v29, s[48:51], 0 offen sc1
    s_mov_b32 s59, 212992
    s_waitcnt vmcnt(20)
    buffer_load_dwordx4 v[144:147], v3, s[36:39], s59 offen offset:0 nt
    s_waitcnt vmcnt(20)
    buffer_load_dwordx4 v[148:151], v3, s[36:39], s59 offen offset:1024 nt
    s_waitcnt vmcnt(20)
    buffer_load_dwordx4 v[152:155], v3, s[36:39], s59 offen offset:2048 nt
    s_waitcnt vmcnt(20)
    buffer_load_dwordx4 v[156:159], v3, s[36:39], s59 offen offset:3072 nt
    s_mov_b32 s59, 229376
    s_waitcnt vmcnt(20)
    buffer_load_dwordx4 v[160:163], v3, s[36:39], s59 offen offset:0 nt
    s_waitcnt vmcnt(20)
    buffer_load_dwordx4 v[164:167], v3, s[36:39], s59 offen offset:1024 nt
    s_waitcnt vmcnt(20)
    buffer_load_dwordx4 v[168:171], v3, s[36:39], s59 offen offset:2048 nt
    s_waitcnt vmcnt(20)
    buffer_load_dwordx4 v[172:175], v3, s[36:39], s59 offen offset:3072 nt
    s_mov_b32 s59, 245760
    s_waitcnt vmcnt(20)
    buffer_load_dwordx4 v[176:179], v3, s[36:39], s59 offen offset:0 nt
    v_mov_b32_dpp v44, v37 quad_perm:[0,0,0,0] row_mask:0xf bank_mask:0xf
    v_mov_b32_dpp v45, v37 quad_perm:[1,1,1,1] row_mask:0xf bank_mask:0xf
    v_mov_b32_dpp v46, v37 quad_perm:[2,2,2,2] row_mask:0xf bank_mask:0xf
    v_mov_b32_dpp v47, v37 quad_perm:[3,3,3,3] row_mask:0xf bank_mask:0xf
    s_waitcnt vmcnt(21)
    v_perm_b32 v48, v112, v96, s70
    v_perm_b32 v52, v112, v96, s71
    v_perm_b32 v56, v113, v97, s70
    v_perm_b32 v60, v113, v97, s71
    v_perm_b32 v64, v114, v98, s70
    v_perm_b32 v68, v114, v98, s71
    v_perm_b32 v72, v115, v99, s70
    v_perm_b32 v76, v115, v99, s71
    s_waitcnt vmcnt(20)
    buffer_load_dwordx4 v[180:183], v3, s[36:39], s59 offen offset:1024 nt
    s_waitcnt vmcnt(21)
    v_perm_b32 v49, v116, v100, s70
    v_perm_b32 v53, v116, v100, s71
    v_perm_b32 v57, v117, v101, s70
    v_perm_b32 v61, v117, v101, s71
    v_perm_b32 v65, v118, v102, s70
    v_perm_b32 v69, v118, v102, s71
    v_perm_b32 v73, v119, v103, s70
    v_perm_b32 v77, v119, v103, s71
    s_waitcnt vmcnt(20)
    buffer_load_dwordx4 v[184:187], v3, s[36:39], s59 offen offset:2048 nt
    s_waitcnt vmcnt(21)
    v_perm_b32 v50, v120, v104, s70
    v_perm_b32 v54, v120, v104, s71
    v_perm_b32 v58, v121, v105, s70
    v_perm_b32 v62, v121, v105, s71
    v_perm_b32 v66, v122, v106, s70
    v_perm_b32 v70, v122, v106, s71
    v_perm_b32 v74, v123, v107, s70
    v_perm_b32 v78, v123, v107, s71
    s_waitcnt vmcnt(20)
    buffer_load_dwordx4 v[188:191], v3, s[36:39], s59 offen offset:3072 nt
    v_lshrrev_b32 v5, 3, v1
    s_lshl_b32 s61, s52, 5
    v_add_u32 v5, s61, v5
    v_lshlrev_b32 v5, 10, v5
    s_and_b32 s61, s52, 1
    s_lshl_b32 s61, s61, 2
    v_and_b32 v6, 7, v1
    v_xor_b32 v6, s61, v6
    v_lshl_add_u32 v5, v6, 4, v5
    v_xor_b32 v6, 32, v5
    s_lshl_b32 s61, s78, 17
    s_lshl_b32 s62, s54, 7
    s_add_u32 s61, s61, s62
    s_lshl_b32 s63, s52, 12
    s_add_u32 m0, s63, 65536
    s_nop 0
    buffer_load_dwordx4 v5, s[44:47], s61 offen nt lds
    s_add_u32 s61, s61, 8192
    s_add_u32 m0, s63, 66560
    s_nop 0
    buffer_load_dwordx4 v6, s[44:47], s61 offen nt lds
    s_add_u32 s61, s61, 8192
    s_add_u32 m0, s63, 67584
    s_nop 0
    buffer_load_dwordx4 v5, s[44:47], s61 offen nt lds
    s_add_u32 s61, s61, 8192
    s_add_u32 m0, s63, 68608
    s_nop 0
    buffer_load_dwordx4 v6, s[44:47], s61 offen nt lds
    s_waitcnt vmcnt(16)
L_ml_chk:
    v_xor_b32 v14, s58, v81
    v_bitop3_b32 v14, v14, v83, s58 bitop3:0xf6
    v_bitop3_b32 v14, v14, v85, s58 bitop3:0xf6
    v_bitop3_b32 v14, v14, v87, s58 bitop3:0xf6
    v_bitop3_b32 v14, v14, v89, s58 bitop3:0xf6
    v_bitop3_b32 v14, v14, v91, s58 bitop3:0xf6
    v_bitop3_b32 v14, v14, v93, s58 bitop3:0xf6
    v_bitop3_b32 v14, v14, v95, s58 bitop3:0xf6
    v_bitop3_b32 v14, v14, v21, s58 bitop3:0xf6
    v_cmp_ne_u32 vcc, 0, v14
    s_nop 0
    s_cbranch_vccz L_ml_ok
    s_cmp_eq_u32 s73, 0
    s_cbranch_scc1 L_ml_ok
    s_sub_u32 s73, s73, 1
    s_and_b32 s61, s73, 255
    s_cbranch_scc1 L_ml_nf
    s_waitcnt vmcnt(0)
    buffer_wbl2 sc1
L_ml_nf:
    s_mov_b64 exec, vcc
    buffer_load_dwordx4 v[80:83], v30, s[48:51], 0 offen offset:0 sc1
    buffer_load_dwordx4 v[84:87], v30, s[48:51], 0 offen offset:128 sc1
    buffer_load_dwordx4 v[88:91], v30, s[48:51], 0 offen offset:256 sc1
    buffer_load_dwordx4 v[92:95], v30, s[48:51], 0 offen offset:384 sc1
    buffer_load_dwordx2 v[20:21], v29, s[48:51], 0 offen sc1
    s_mov_b64 exec, -1
    s_waitcnt vmcnt(0)
    s_branch L_ml_chk
L_ml_ok:
    s_mov_b32 s74, 0
    v_cmp_ne_u32 vcc, s56, v20
    s_nop 0
    s_cbranch_vccz L_samedie
    s_mov_b32 s74, 1
    s_waitcnt vmcnt(0)
    buffer_wbl2 sc1
    s_waitcnt vmcnt(0)
    s_lshl_b32 s61, s77, 4
    s_lshl_b32 s62, s52, 2
    s_add_u32 s61, s61, s62
    s_add_u32 s61, s61, 294912
    v_mov_b32 v7, s61
    v_mov_b32 v14, s58
    s_mov_b64 exec, 1
    buffer_store_dword v14, v7, s[48:51], 0 offen sc1
    s_mov_b64 exec, -1
    s_lshl_b32 s61, s53, 9
    s_add_u32 s61, s61, 294912
    v_lshl_add_u32 v7, v1, 3, s61
    buffer_load_dwordx2 v[20:21], v7, s[48:51], 0 offen sc1
    s_waitcnt vmcnt(0)
L_fl_chk:
    v_xor_b32 v14, s58, v20
    v_bitop3_b32 v14, v14, v21, s58 bitop3:0xf6
    v_cmp_ne_u32 vcc, 0, v14
    s_nop 0
    s_cbranch_vccz L_fl_ok
    s_cmp_eq_u32 s73, 0
    s_cbranch_scc1 L_fl_ok
    s_sub_u32 s73, s73, 1
    s_mov_b64 exec, vcc
    buffer_load_dwordx2 v[20:21], v7, s[48:51], 0 offen sc1
    s_mov_b64 exec, -1
    s_waitcnt vmcnt(0)
    s_branch L_fl_chk
L_fl_ok:
L_samedie:
    v_max3_f32 v14, v80, v84, v88
    v_max_f32 v14, v14, v92
    v_sub_f32 v80, v80, v14
    v_sub_f32 v84, v84, v14
    v_sub_f32 v88, v88, v14
    v_sub_f32 v92, v92, v14
    v_exp_f32 v80, v80
    v_exp_f32 v84, v84
    v_exp_f32 v88, v88
    v_exp_f32 v92, v92
    v_mul_f32 v14, v80, v82
    v_fmac_f32 v14, v84, v86
    v_fmac_f32 v14, v88, v90
    v_fmac_f32 v14, v92, v94
    v_rcp_f32 v14, v14
    v_mov_b32 v42, 0xfffffc00
    v_mul_f32 v80, v80, v14
    v_mul_f32 v84, v84, v14
    v_mul_f32 v88, v88, v14
    v_mul_f32 v92, v92, v14
    s_waitcnt vmcnt(25)
    v_perm_b32 v51, v124, v108, s70
    v_perm_b32 v55, v124, v108, s71
    v_perm_b32 v59, v125, v109, s70
    v_mfma_f32_16x16x32_bf16 a[32:35], v[44:47], v[48:51], a[32:35]
    v_perm_b32 v63, v125, v109, s71
    v_mfma_f32_16x16x32_bf16 a[36:39], v[44:47], v[52:55], a[36:39]
    v_perm_b32 v67, v126, v110, s70
    v_mfma_f32_16x16x32_bf16 a[40:43], v[44:47], v[56:59], a[40:43]
    v_perm_b32 v71, v126, v110, s71
    v_mfma_f32_16x16x32_bf16 a[44:47], v[44:47], v[60:63], a[44:47]
    v_perm_b32 v75, v127, v111, s70
    v_mfma_f32_16x16x32_bf16 a[48:51], v[44:47], v[64:67], a[48:51]
    v_perm_b32 v79, v127, v111, s71
    v_mfma_f32_16x16x32_bf16 a[52:55], v[44:47], v[68:71], a[52:55]
    v_mfma_f32_16x16x32_bf16 a[56:59], v[44:47], v[72:75], a[56:59]
    v_mfma_f32_16x16x32_bf16 a[60:63], v[44:47], v[76:79], a[60:63]
    v_mov_b32_dpp v44, v38 quad_perm:[0,0,0,0] row_mask:0xf bank_mask:0xf
    v_mov_b32_dpp v45, v38 quad_perm:[1,1,1,1] row_mask:0xf bank_mask:0xf
    v_mov_b32_dpp v46, v38 quad_perm:[2,2,2,2] row_mask:0xf bank_mask:0xf
    v_mov_b32_dpp v47, v38 quad_perm:[3,3,3,3] row_mask:0xf bank_mask:0xf
    s_waitcnt vmcnt(15)
    v_perm_b32 v48, v144, v128, s70
    v_perm_b32 v52, v144, v128, s71
    v_perm_b32 v56, v145, v129, s70
    v_perm_b32 v60, v145, v129, s71
    v_perm_b32 v64, v146, v130, s70
    v_perm_b32 v68, v146, v130, s71
    v_perm_b32 v72, v147, v131, s70
    v_perm_b32 v76, v147, v131, s71
    s_waitcnt vmcnt(14)
    v_perm_b32 v49, v148, v132, s70
    v_perm_b32 v53, v148, v132, s71
    v_perm_b32 v57, v149, v133, s70
    v_perm_b32 v61, v149, v133, s71
    v_perm_b32 v65, v150, v134, s70
    v_perm_b32 v69, v150, v134, s71
    v_perm_b32 v73, v151, v135, s70
    v_perm_b32 v77, v151, v135, s71
    s_waitcnt vmcnt(13)
    v_perm_b32 v50, v152, v136, s70
    v_perm_b32 v54, v152, v136, s71
    v_perm_b32 v58, v153, v137, s70
    v_perm_b32 v62, v153, v137, s71
    v_perm_b32 v66, v154, v138, s70
    v_perm_b32 v70, v154, v138, s71
    v_perm_b32 v74, v155, v139, s70
    v_perm_b32 v78, v155, v139, s71
    s_waitcnt vmcnt(12)
    v_perm_b32 v51, v156, v140, s70
    v_perm_b32 v55, v156, v140, s71
    v_perm_b32 v59, v157, v141, s70
    v_mfma_f32_16x16x32_bf16 a[32:35], v[44:47], v[48:51], a[32:35]
    v_perm_b32 v63, v157, v141, s71
    v_mfma_f32_16x16x32_bf16 a[36:39], v[44:47], v[52:55], a[36:39]
    v_perm_b32 v67, v158, v142, s70
    v_mfma_f32_16x16x32_bf16 a[40:43], v[44:47], v[56:59], a[40:43]
    v_perm_b32 v71, v158, v142, s71
    v_mfma_f32_16x16x32_bf16 a[44:47], v[44:47], v[60:63], a[44:47]
    v_perm_b32 v75, v159, v143, s70
    v_mfma_f32_16x16x32_bf16 a[48:51], v[44:47], v[64:67], a[48:51]
    v_perm_b32 v79, v159, v143, s71
    v_mfma_f32_16x16x32_bf16 a[52:55], v[44:47], v[68:71], a[52:55]
    v_mfma_f32_16x16x32_bf16 a[56:59], v[44:47], v[72:75], a[56:59]
    v_mfma_f32_16x16x32_bf16 a[60:63], v[44:47], v[76:79], a[60:63]
    v_mov_b32_dpp v44, v39 quad_perm:[0,0,0,0] row_mask:0xf bank_mask:0xf
    v_mov_b32_dpp v45, v39 quad_perm:[1,1,1,1] row_mask:0xf bank_mask:0xf
    v_mov_b32_dpp v46, v39 quad_perm:[2,2,2,2] row_mask:0xf bank_mask:0xf
    v_mov_b32_dpp v47, v39 quad_perm:[3,3,3,3] row_mask:0xf bank_mask:0xf
    s_waitcnt vmcnt(7)
    v_perm_b32 v48, v176, v160, s70
    v_perm_b32 v52, v176, v160, s71
    v_perm_b32 v56, v177, v161, s70
    v_perm_b32 v60, v177, v161, s71
    v_perm_b32 v64, v178, v162, s70
    v_perm_b32 v68, v178, v162, s71
    v_perm_b32 v72, v179, v163, s70
    v_perm_b32 v76, v179, v163, s71
    s_waitcnt vmcnt(6)
    v_perm_b32 v49, v180, v164, s70
    v_perm_b32 v53, v180, v164, s71
    v_perm_b32 v57, v181, v165, s70
    v_perm_b32 v61, v181, v165, s71
    v_perm_b32 v65, v182, v166, s70
    v_perm_b32 v69, v182, v166, s71
    v_perm_b32 v73, v183, v167, s70
    v_perm_b32 v77, v183, v167, s71
    s_waitcnt vmcnt(5)
    v_perm_b32 v50, v184, v168, s70
    v_perm_b32 v54, v184, v168, s71
    v_perm_b32 v58, v185, v169, s70
    v_perm_b32 v62, v185, v169, s71
    v_perm_b32 v66, v186, v170, s70
    v_perm_b32 v70, v186, v170, s71
    v_perm_b32 v74, v187, v171, s70
    v_perm_b32 v78, v187, v171, s71
    s_waitcnt vmcnt(4)
    v_perm_b32 v51, v188, v172, s70
    v_perm_b32 v55, v188, v172, s71
    v_perm_b32 v59, v189, v173, s70
    v_mfma_f32_16x16x32_bf16 a[32:35], v[44:47], v[48:51], a[32:35]
    v_perm_b32 v63, v189, v173, s71
    v_mfma_f32_16x16x32_bf16 a[36:39], v[44:47], v[52:55], a[36:39]
    v_perm_b32 v67, v190, v174, s70
    v_mfma_f32_16x16x32_bf16 a[40:43], v[44:47], v[56:59], a[40:43]
    v_perm_b32 v71, v190, v174, s71
    v_mfma_f32_16x16x32_bf16 a[44:47], v[44:47], v[60:63], a[44:47]
    v_perm_b32 v75, v191, v175, s70
    v_mfma_f32_16x16x32_bf16 a[48:51], v[44:47], v[64:67], a[48:51]
    v_perm_b32 v79, v191, v175, s71
    v_mfma_f32_16x16x32_bf16 a[52:55], v[44:47], v[68:71], a[52:55]
    v_mfma_f32_16x16x32_bf16 a[56:59], v[44:47], v[72:75], a[56:59]
    v_mfma_f32_16x16x32_bf16 a[60:63], v[44:47], v[76:79], a[60:63]
    ds_write2st64_b32 v27, a32, a36 offset0:0 offset1:1
    s_nop 0
    ds_write2st64_b32 v27, a40, a44 offset0:2 offset1:3
    s_nop 2
    ds_write2st64_b32 v27, a48, a52 offset0:4 offset1:5
    s_nop 0
    ds_write2st64_b32 v27, a56, a60 offset0:6 offset1:7
    s_waitcnt lgkmcnt(0)
    s_barrier
    ds_read2st64_b32 v[48:49], v28 offset0:0 offset1:1
    ds_read2st64_b32 v[50:51], v28 offset0:8 offset1:9
    ds_read2st64_b32 v[52:53], v28 offset0:16 offset1:17
    ds_read2st64_b32 v[54:55], v28 offset0:24 offset1:25
    s_cmp_eq_u32 s74, 0
    s_waitcnt lgkmcnt(0)
    v_pk_add_f32 v[48:49], v[48:49], v[50:51]
    v_pk_add_f32 v[52:53], v[52:53], v[54:55]
    v_pk_add_f32 v[48:49], v[48:49], v[52:53]
    v_cvt_pk_bf16_f32 v48, v48, v49
    v_min_u32 v48, -2, v48
    s_cbranch_scc0 L_st_far
    buffer_store_dword v48, v8, s[48:51], 0 offen
L_st_done:
    s_waitcnt vmcnt(0)
    s_barrier
    buffer_load_dwordx4 v[192:195], v24, s[48:51], 0 offen offset:0 sc1
    buffer_load_dwordx4 v[196:199], v24, s[48:51], 0 offen offset:1024 sc1
    buffer_load_dwordx4 v[200:203], v24, s[48:51], 0 offen offset:2048 sc1
    buffer_load_dwordx4 v[204:207], v24, s[48:51], 0 offen offset:3072 sc1
    ds_read_b64_tr_b16 a[64:65], v4 offset:0
    ds_read_b64_tr_b16 a[66:67], v4 offset:2048
    ds_read_b64_tr_b16 a[80:81], v13 offset:0
    ds_read_b64_tr_b16 a[82:83], v13 offset:2048
    ds_read_b64_tr_b16 a[68:69], v4 offset:256
    ds_read_b64_tr_b16 a[70:71], v4 offset:2304
    ds_read_b64_tr_b16 a[84:85], v13 offset:256
    ds_read_b64_tr_b16 a[86:87], v13 offset:2304
    ds_read_b64_tr_b16 a[72:73], v4 offset:512
    ds_read_b64_tr_b16 a[74:75], v4 offset:2560
    ds_read_b64_tr_b16 a[88:89], v13 offset:512
    ds_read_b64_tr_b16 a[90:91], v13 offset:2560
    ds_read_b64_tr_b16 a[76:77], v4 offset:768
    ds_read_b64_tr_b16 a[78:79], v4 offset:2816
    ds_read_b64_tr_b16 a[92:93], v13 offset:768
    ds_read_b64_tr_b16 a[94:95], v13 offset:2816
    s_waitcnt vmcnt(0) lgkmcnt(0)
L_p1_chk:
    v_max3_u32 v72, v192, v193, v194
    v_max3_u32 v73, v195, v196, v197
    v_max3_u32 v74, v198, v199, v200
    v_max3_u32 v75, v201, v202, v203
    v_max3_u32 v76, v204, v205, v206
    v_max3_u32 v72, v72, v73, v74
    v_max3_u32 v75, v75, v76, v207
    v_max_u32 v14, v72, v75
    v_cmp_eq_u32 vcc, -1, v14
    s_nop 0
    s_cbranch_vccz L_p1_ok
    s_cmp_eq_u32 s73, 0
    s_cbranch_scc1 L_p1_ok
    s_sub_u32 s73, s73, 1
    s_mov_b64 exec, vcc
    buffer_load_dwordx4 v[192:195], v24, s[48:51], 0 offen offset:0 sc1
    buffer_load_dwordx4 v[196:199], v24, s[48:51], 0 offen offset:1024 sc1
    buffer_load_dwordx4 v[200:203], v24, s[48:51], 0 offen offset:2048 sc1
    buffer_load_dwordx4 v[204:207], v24, s[48:51], 0 offen offset:3072 sc1
    s_mov_b64 exec, -1
    s_waitcnt vmcnt(0)
    s_branch L_p1_chk
L_p1_ok:
    v_mfma_f32_16x16x32_bf16 v[64:67], v[192:195], a[64:67], 0
    v_mfma_f32_16x16x32_bf16 v[68:71], v[192:195], a[80:83], 0
    v_mfma_f32_16x16x32_bf16 v[64:67], v[196:199], a[68:71], v[64:67]
    v_mfma_f32_16x16x32_bf16 v[68:71], v[196:199], a[84:87], v[68:71]
    v_mfma_f32_16x16x32_bf16 v[64:67], v[200:203], a[72:75], v[64:67]
    v_mfma_f32_16x16x32_bf16 v[68:71], v[200:203], a[88:91], v[68:71]
    v_mfma_f32_16x16x32_bf16 v[64:67], v[204:207], a[76:79], v[64:67]
    v_mfma_f32_16x16x32_bf16 v[68:71], v[204:207], a[92:95], v[68:71]
    s_nop 6
    v_mul_f32 v40, v64, v80
    v_mul_f32 v41, v68, v80
    v_fmac_f32 v40, v65, v84
    v_fmac_f32 v41, v69, v84
    v_fmac_f32 v40, v66, v88
    v_fmac_f32 v41, v70, v88
    v_fmac_f32 v40, v67, v92
    v_fmac_f32 v41, v71, v92
    v_and_or_b32 v40, v40, v42, s75
    v_and_or_b32 v41, v41, v42, s75
    s_nop 0
    v_mov_b32_dpp v42, v40 quad_perm:[1,1,3,3] row_mask:0xf bank_mask:0xf
    v_mov_b32_dpp v43, v41 quad_perm:[1,1,3,3] row_mask:0xf bank_mask:0xf
    s_mov_b32 exec_lo, 0x55555555
    s_mov_b32 exec_hi, 0x55555555
    s_barrier
    buffer_store_dwordx4 v[40:43], v25, s[48:51], 0 offen sc1
    s_mov_b64 exec, -1
    s_cmp_eq_u32 s52, 3
    s_cbranch_scc0 L_fin
    v_lshlrev_b32 v48, 16, v208
    v_and_b32 v49, 0xffff0000, v208
    v_lshlrev_b32 v56, 16, v212
    v_and_b32 v57, 0xffff0000, v212
    v_lshlrev_b32 v50, 16, v209
    v_and_b32 v51, 0xffff0000, v209
    v_lshlrev_b32 v58, 16, v213
    v_and_b32 v59, 0xffff0000, v213
    v_lshlrev_b32 v52, 16, v210
    v_and_b32 v53, 0xffff0000, v210
    v_lshlrev_b32 v60, 16, v214
    v_and_b32 v61, 0xffff0000, v214
    v_lshlrev_b32 v54, 16, v211
    v_and_b32 v55, 0xffff0000, v211
    v_lshlrev_b32 v62, 16, v215
    v_and_b32 v63, 0xffff0000, v215
    v_mul_f32 v48, v48, v56
    v_mul_f32 v49, v49, v57
    v_mul_f32 v50, v50, v58
    v_mul_f32 v51, v51, v59
    v_mul_f32 v52, v52, v60
    v_mul_f32 v53, v53, v61
    v_mul_f32 v54, v54, v62
    v_mul_f32 v55, v55, v63
    v_cvt_pk_bf16_f32 v56, v48, v49
    v_cvt_pk_bf16_f32 v57, v50, v51
    v_cvt_pk_bf16_f32 v58, v52, v53
    v_cvt_pk_bf16_f32 v59, v54, v55
    v_lshlrev_b32 v48, 16, v56
    v_and_b32 v49, 0xffff0000, v56
    v_lshlrev_b32 v50, 16, v57
    v_and_b32 v51, 0xffff0000, v57
    v_lshlrev_b32 v52, 16, v58
    v_and_b32 v53, 0xffff0000, v58
    v_lshlrev_b32 v54, 16, v59
    v_and_b32 v55, 0xffff0000, v59
    v_add_f32 v48, v48, v52
    v_add_f32 v49, v49, v53
    v_add_f32 v50, v50, v54
    v_add_f32 v51, v51, v55
    v_add_f32 v48, v48, v50
    v_add_f32 v49, v49, v51
    v_add_f32 v48, v48, v49
    s_nop 1
    v_add_f32_dpp v48, v48, v48 quad_perm:[1,0,3,2] row_mask:0xf bank_mask:0xf
    s_nop 1
    v_add_f32_dpp v48, v48, v48 quad_perm:[2,3,0,1] row_mask:0xf bank_mask:0xf
    s_nop 1
    v_add_f32_dpp v48, v48, v48 row_ror:4 row_mask:0xf bank_mask:0xf
    s_nop 1
    v_add_f32_dpp v48, v48, v48 row_ror:8 row_mask:0xf bank_mask:0xf
    v_mov_b32 v49, v48
    s_nop 1
    v_permlane16_swap_b32 v48, v49
    v_add_f32 v48, v48, v49
    v_mov_b32 v49, v48
    s_nop 1
    v_permlane32_swap_b32 v48, v49
    v_add_f32 v48, v48, v49
    v_cvt_pk_bf16_f32 v48, v48, v48
    v_and_b32 v48, 0xffff0000, v48
    v_mul_f32 v48, 0xbfb8aa3b, v48
    v_exp_f32 v48, v48
    s_nop 0
    v_add_f32 v48, 1.0, v48
    v_rcp_f32 v48, v48
    s_nop 0
    v_cvt_pk_bf16_f32 v9, v48, v48
    v_and_b32 v9, 0xffff0000, v9
    v_sub_f32 v10, 1.0, v9
    v_cvt_pk_bf16_f32 v10, v10, v10
    v_and_b32 v10, 0xffff0000, v10
    v_lshlrev_b32 v11, 16, v11
    s_waitcnt vmcnt(0)
    buffer_load_dwordx4 v[96:99], v26, s[48:51], 0 offen offset:0 sc1
    buffer_load_dwordx4 v[100:103], v26, s[48:51], 0 offen offset:2048 sc1
L_f_chk:
    v_xor_b32 v14, s58, v17
    v_bitop3_b32 v14, v14, v19, s58 bitop3:0xf6
    v_cmp_ne_u32 vcc, 0, v14
    s_nop 0
    s_cbranch_vccz L_f_ok
    s_cmp_eq_u32 s73, 0
    s_cbranch_scc1 L_f_ok
    s_sub_u32 s73, s73, 1
    s_mov_b64 exec, vcc
    s_movk_i32 s61, 16384
    buffer_load_dwordx2 v[16:17], v31, s[48:51], 0 offen sc1
    s_and_b32 exec_lo, exec_lo, 0x0fff0fff
    s_and_b32 exec_hi, exec_hi, 0x0fff0fff
    s_cbranch_execz L_fg_skipRL_f
    buffer_load_dwordx2 v[18:19], v31, s[48:51], s61 offen sc1
L_fg_skipRL_f:
    s_mov_b64 exec, -1
    s_mov_b64 exec, -1
    s_waitcnt vmcnt(0)
    s_branch L_f_chk
L_f_ok:
    v_add_f32 v16, v16, v18
    s_nop 1
    v_add_f32_dpp v16, v16, v16 row_ror:4 row_mask:0xf bank_mask:0xf
    s_nop 1
    v_add_f32_dpp v16, v16, v16 row_ror:8 row_mask:0xf bank_mask:0xf
    v_cvt_pk_bf16_f32 v16, v16, v16
    v_and_b32 v16, 0xffff0000, v16
    v_add_f32 v16, v16, v11
    v_cvt_pk_bf16_f32 v16, v16, v16
    v_and_b32 v16, 0xffff0000, v16
    v_mul_f32 v16, v16, v10
    v_cvt_pk_bf16_f32 v16, v16, v16
    v_and_b32 v16, 0xffff0000, v16
    buffer_load_dwordx4 v[104:107], v26, s[48:51], 0 offen offset:0 sc1
    buffer_load_dwordx4 v[108:111], v26, s[48:51], 0 offen offset:2048 sc1
    v_mov_b32 v120, 0x3ff
L_p2_chk:
    s_waitcnt vmcnt(2)
    v_bitop3_b32 v116, v96, v97, s58 bitop3:0x7e
    v_bitop3_b32 v117, v98, v99, s58 bitop3:0x7e
    v_bitop3_b32 v118, v100, v101, s58 bitop3:0x7e
    v_bitop3_b32 v119, v102, v103, s58 bitop3:0x7e
    v_or3_b32 v116, v116, v117, v118
    v_pk_add_f32 v[112:113], v[96:97], v[100:101]
    v_bitop3_b32 v116, v116, v119, v120 bitop3:0xa8
    v_pk_add_f32 v[114:115], v[98:99], v[102:103]
    v_cmp_ne_u32 vcc, 0, v116
    s_nop 0
    s_cbranch_vccz L_p2_sum
    s_mov_b64 exec, vcc
    buffer_load_dwordx4 v[96:99], v26, s[48:51], 0 offen offset:0 sc1
    buffer_load_dwordx4 v[100:103], v26, s[48:51], 0 offen offset:2048 sc1
    s_mov_b64 exec, -1
    s_waitcnt vmcnt(2)
    v_bitop3_b32 v116, v104, v105, s58 bitop3:0x7e
    v_bitop3_b32 v117, v106, v107, s58 bitop3:0x7e
    v_bitop3_b32 v118, v108, v109, s58 bitop3:0x7e
    v_bitop3_b32 v119, v110, v111, s58 bitop3:0x7e
    v_or3_b32 v116, v116, v117, v118
    v_pk_add_f32 v[112:113], v[104:105], v[108:109]
    v_bitop3_b32 v116, v116, v119, v120 bitop3:0xa8
    v_pk_add_f32 v[114:115], v[106:107], v[110:111]
    v_cmp_ne_u32 vcc, 0, v116
    s_nop 0
    s_cbranch_vccz L_p2_sum
    s_mov_b64 exec, vcc
    buffer_load_dwordx4 v[104:107], v26, s[48:51], 0 offen offset:0 sc1
    buffer_load_dwordx4 v[108:111], v26, s[48:51], 0 offen offset:2048 sc1
    s_mov_b64 exec, -1
    s_cmp_eq_u32 s73, 0
    s_cbranch_scc1 L_p2_sum
    s_sub_u32 s73, s73, 1
    s_branch L_p2_chk
L_p2_sum:
    v_permlane16_swap_b32 v112, v113
    v_permlane16_swap_b32 v114, v115
    v_add_f32 v112, v112, v113
    v_add_f32 v114, v114, v115
    s_nop 1
    v_permlane32_swap_b32 v112, v114
    v_add_f32 v112, v112, v114
    s_nop 1
    v_add_f32_dpp v112, v112, v112 row_ror:4 row_mask:0xf bank_mask:0xf
    s_nop 1
    v_add_f32_dpp v112, v112, v112 row_ror:8 row_mask:0xf bank_mask:0xf
    v_cvt_pk_bf16_f32 v112, v112, v112
    v_and_b32 v112, 0xffff0000, v112
    v_mul_f32 v112, v112, v9
    v_cvt_pk_bf16_f32 v112, v112, v112
    v_and_b32 v112, 0xffff0000, v112
    v_add_f32 v112, v112, v16
    v_cvt_pk_bf16_f32 v112, v112, v112
    s_mov_b32 exec_lo, 0x000f000f
    s_mov_b32 exec_hi, 0x000f000f
    global_store_short v12, v112, s[26:27]
    s_cmp_eq_u32 s2, 0
    s_cbranch_scc0 L_noep
    s_mov_b64 exec, 1
    v_mov_b32 v113, s58
    v_mov_b32 v114, 0
    buffer_store_dword v113, v114, s[48:51], 0 offen
L_noep:
    s_mov_b64 exec, -1
L_fin:
L_end:
    s_endpgm
L_st_far:
    buffer_store_dword v48, v8, s[48:51], 0 offen sc1
    s_branch L_st_done
.section .rodata,"a"
.p2align 6
.amdhsa_kernel gated_mix__gqa_block_cached__dense_activation_gelu__decode_kernel
  .amdhsa_next_free_vgpr 512
  .amdhsa_next_free_sgpr 102
  .amdhsa_accum_offset 256
  .amdhsa_group_segment_fixed_size 0
  .amdhsa_kernarg_size 112
  .amdhsa_user_sgpr_count 2
  .amdhsa_user_sgpr_kernarg_segment_ptr 1
  .amdhsa_system_sgpr_workgroup_id_x 1
.end_amdhsa_kernel
```
